```python
import torch

def _softmax(x, axis=-1):
    return torch.softmax(x, dim=axis)
def _gelu(x):
    return torch.nn.functional.gelu(x, approximate="tanh")
def _silu(x):
    return torch.nn.functional.silu(x)
def _sigmoid(x):
    return torch.sigmoid(x)
def _layernorm(x, axis=-1, eps=1e-5):
    m = x.mean(dim=axis, keepdim=True)
    v = x.var(dim=axis, keepdim=True, unbiased=False)
    return (x - m) / torch.sqrt(v + eps)
def _scatter_add(tgt, idx, src, axis=0):
    return tgt.clone().index_add_(axis, idx, src)
def _segment_sum(src, seg, n):
    out = torch.zeros((n,) + src.shape[1:], dtype=src.dtype)
    return out.index_add_(0, seg, src)
def _pad(x, pw):
    flat = tuple(v for pair in reversed(pw) for v in pair)
    return torch.nn.functional.pad(x, flat)

kernel_name = 'standalone__gqa_softmax__near_ridge'

def setup_inputs():

    _w = (lambda a: (lambda t: t.to(torch.bfloat16) if t.is_floating_point() else t)(torch.as_tensor(a)))
    B, Hq, Hkv, Sq, Sk, D = 8, 32, 8, 96, 2048, 128
    return {
        "q": _w((lambda *s: torch.randn(*s, dtype=torch.bfloat16) * 0.8)(B, Hq, Sq, D)),
        "k": _w((lambda *s: torch.randn(*s, dtype=torch.bfloat16) * 0.8)(B, Hkv, Sk, D)),
        "v": _w((lambda *s: torch.randn(*s, dtype=torch.bfloat16) * 0.05)(B, Hkv, Sk, D)),
    }

def reference(q, k, v):
    B, Hq, Sq, D = q.shape
    Hkv = k.shape[1]
    rep = Hq // Hkv
    k = (lambda x, n, axis: torch.repeat_interleave(x, n, dim=axis))(k, rep, axis=1)
    v = (lambda x, n, axis: torch.repeat_interleave(x, n, dim=axis))(v, rep, axis=1)
    scale = D ** -0.5
    scores = torch.einsum("bhqd,bhkd->bhqk", q, k) * scale
    p = _softmax(scores, axis=-1)
    return torch.einsum("bhqk,bhkd->bhqd", p, v)
```

```asm
; @launch grid=(256,1,1) block=(256,1,1) lds=163840
.amdgcn_target "amdgcn-amd-amdhsa--gfx950"
.text
.globl standalone__gqa_softmax__near_ridge_kernel
.p2align 12
.p2align 8
.type standalone__gqa_softmax__near_ridge_kernel,@function
standalone__gqa_softmax__near_ridge_kernel:
    s_cmp_ge_u32 s2, 0x100
    s_cbranch_scc1 L_end
    s_load_dwordx8 s[4:11], s[0:1], 0
    v_lshrrev_b32 v1, 6, v0
    v_lshlrev_b32 v7, 4, v0
    v_readfirstlane_b32 s32, v1
    v_and_b32 v0, 63, v0
    s_and_b32 s38, s2, 7
    s_lshr_b32 s39, s2, 3
    s_lshr_b32 s40, s39, 2
    s_lshl_b32 s38, s38, 3
    s_add_u32 s38, s38, s40
    s_and_b32 s39, s39, 3
    s_lshl_b32 s40, s38, 2
    s_add_u32 s40, s40, s39
    s_mul_i32 s41, s40, 0x6000
    s_lshl_b32 s42, s38, 19
    s_mul_i32 s33, s32, 0xa000
    s_lshl_b32 s43, s32, 17
    s_add_u32 s42, s42, s43
    s_lshl_b32 s44, s32, 2
    s_add_u32 s44, s44, s38
    s_and_b32 s44, s44, 15
    s_mul_i32 s44, s44, 0x2000
    s_add_u32 s45, s44, 0x1000
    s_add_u32 s46, s44, 0x2000
    s_and_b32 s46, s46, 0x1ffff
    s_add_u32 s47, s46, 0x1000
    s_and_b32 s100, s38, 0
    s_lshl_b32 s100, s100, 2
    s_add_u32 s100, s100, s39
    s_mov_b32 s53, 0x1000
    s_mov_b32 s54, 0x2000
    s_mov_b32 s55, 0x3000
    s_mov_b32 s56, 0x4000
    s_mov_b32 s57, 0x5000
    s_mov_b32 s26, 0x6000
    s_mov_b32 s27, 0x20000
    s_mov_b32 s18, 0x20000
    s_mov_b32 s19, 0x20000
    s_mov_b32 s22, 0x20000
    s_mov_b32 s23, 0x20000
    s_mov_b32 s30, 0x6000
    s_mov_b32 s31, 0x20000
    v_lshrrev_b32 v1, 4, v0
    v_and_b32 v2, 15, v0
    v_xor_b32 v3, v1, v2
    v_lshlrev_b32 v3, 4, v3
    v_lshl_add_u32 v20, v1, 8, v3
    v_xor_b32 v21, 64, v20
    v_xor_b32 v22, 0x80, v20
    v_xor_b32 v23, 0xc0, v20
    v_lshlrev_b32 v4, 1, v1
    v_xor_b32 v4, v4, v2
    v_lshlrev_b32 v4, 4, v4
    v_lshl_add_u32 v24, v1, 8, v4
    v_xor_b32 v25, 0x80, v24
    s_waitcnt lgkmcnt(0)
    s_add_u32 s24, s4, s41
    s_addc_u32 s25, s5, 0
    s_add_u32 s16, s6, s42
    s_addc_u32 s17, s7, 0
    s_add_u32 s20, s8, s42
    s_addc_u32 s21, s9, 0
    s_add_u32 s28, s10, s41
    s_addc_u32 s29, s11, 0
    s_bfe_u32 s43, s2, 0x10005
    s_lshl_b32 s43, s43, 2
    s_add_u32 s43, s43, s32
    s_mov_b32 s34, 0
L_again:
    buffer_load_dwordx4 v[40:43], v7, s[24:27], 0 offen nt
    s_mov_b32 s41, 0x76543210
    s_mov_b32 s42, 0xfedcba98
    s_cmp_eq_u32 s100, 1
    s_cmov_b32 s41, 0x67453210
    s_cmov_b32 s42, 0xefcdab89
    s_cmp_eq_u32 s100, 2
    s_cmov_b32 s41, 0x76543210
    s_cmov_b32 s42, 0xfedcba98
    s_cmp_eq_u32 s100, 3
    s_cmov_b32 s41, 0x67453210
    s_cmov_b32 s42, 0xefcdab89
    s_mov_b32 m0, s33
    s_nop 0
    buffer_load_dwordx4 v20, s[16:19], s44 offen nt lds
    s_bfe_u32 s48, s41, 0x40008
    s_mul_i32 s48, s48, 0x2000
    s_add_u32 s48, s48, s44
    s_and_b32 s48, s48, 0x1ffff
    s_add_u32 s49, s48, 0x1000
    s_mov_b32 s36, 0x3e0293ee
    s_mov_b32 s37, s36
    buffer_load_dwordx4 v[44:47], v7, s[24:27], s53 offen nt
    s_mov_b32 s35, 0x5d5e0b6b
    v_lshrrev_b32 v1, 4, v0
    v_and_b32 v2, 15, v0
    v_xor_b32 v3, v1, v2
    v_lshlrev_b32 v3, 4, v3
    v_lshl_add_u32 v4, v2, 8, v3
    v_xor_b32 v80, 0, v4
    v_add_u32 v8, s33, v80
    v_add_u32 v84, 0x1c000, v80
    buffer_load_dwordx4 v21, s[16:19], s44 offen offset:1024 nt lds
    v_add_u32 v80, 0x8000, v80
    v_xor_b32 v81, 64, v4
    v_add_u32 v9, s33, v81
    v_add_u32 v85, 0x1c000, v81
    v_add_u32 v81, 0x8000, v81
    v_xor_b32 v82, 0x80, v4
    v_add_u32 v10, s33, v82
    v_add_u32 v86, 0x1c000, v82
    v_add_u32 v82, 0x8000, v82
    buffer_load_dwordx4 v[48:51], v7, s[24:27], s54 offen nt
    v_xor_b32 v83, 0xc0, v4
    v_add_u32 v11, s33, v83
    v_add_u32 v87, 0x1c000, v83
    v_add_u32 v83, 0x8000, v83
    s_lshl_b32 s38, s32, 6
    s_lshl_b32 s39, s32, 10
    s_add_u32 s39, s39, 0x8000
    v_xor_b32 v30, s38, v20
    v_add_u32 v30, s39, v30
    buffer_load_dwordx4 v22, s[16:19], s44 offen offset:2048 nt lds
    v_add_u32 v31, 0x14000, v30
    v_lshrrev_b32 v5, 2, v0
    v_and_b32 v6, 3, v0
    v_lshlrev_b32 v6, 3, v6
    v_lshl_add_u32 v6, v5, 8, v6
    v_and_b32 v5, 7, v5
    s_lshl_b32 s38, s32, 1
    v_xor_b32 v5, s38, v5
    v_lshl_add_u32 v6, v5, 5, v6
    buffer_load_dwordx4 v[52:55], v7, s[24:27], s55 offen nt
    v_xor_b32 v12, 0, v6
    v_add_u32 v12, s33, v12
    v_xor_b32 v13, 32, v6
    v_add_u32 v13, s33, v13
    v_xor_b32 v14, 64, v6
    v_add_u32 v14, s33, v14
    v_xor_b32 v15, 0x60, v6
    v_add_u32 v15, s33, v15
    v_xor_b32 v16, 0x80, v6
    buffer_load_dwordx4 v23, s[16:19], s44 offen offset:3072 nt lds
    v_add_u32 v16, s33, v16
    v_xor_b32 v17, 0xa0, v6
    v_add_u32 v17, s33, v17
    v_xor_b32 v18, 0xc0, v6
    v_add_u32 v18, s33, v18
    v_xor_b32 v19, 0xe0, v6
    v_add_u32 v19, s33, v19
    v_lshlrev_b32 v26, 5, v2
    v_lshlrev_b32 v27, 4, v0
    buffer_load_dwordx4 v[56:59], v7, s[24:27], s56 offen nt
    v_lshlrev_b32 v32, 4, v1
    v_mov_b32 v36, 0x3f803f80
    v_lshrrev_b32 v6, 5, v0
    v_and_b32 v5, 1, v0
    v_cmp_eq_u32 vcc, v5, v6
    v_bfe_u32 v6, v0, 1, 1
    v_mul_u32_u24 v6, 0xaaaa, v6
    v_add_u32 v6, 0x4444, v6
    v_mov_b32 v5, 0
    s_add_u32 m0, s33, 0x1000
    s_nop 0
    buffer_load_dwordx4 v20, s[16:19], s45 offen nt lds
    v_cndmask_b32 v36, v5, v36, vcc
    v_accvgpr_write_b32 a240, v36
    v_accvgpr_write_b32 a241, v36
    v_accvgpr_write_b32 a242, v36
    v_accvgpr_write_b32 a243, v36
    buffer_load_dwordx4 v[60:63], v7, s[24:27], s57 offen nt
    s_waitcnt vmcnt(10)
    v_lshlrev_b32 v64, 16, v40
    v_and_b32 v65, 0xffff0000, v40
    v_lshlrev_b32 v66, 16, v41
    v_and_b32 v67, 0xffff0000, v41
    v_lshlrev_b32 v68, 16, v42
    v_and_b32 v69, 0xffff0000, v42
    v_lshlrev_b32 v70, 16, v43
    v_and_b32 v71, 0xffff0000, v43
    v_pk_mul_f32 v[64:65], v[64:65], s[36:37]
    v_pk_mul_f32 v[66:67], v[66:67], s[36:37]
    v_pk_mul_f32 v[68:69], v[68:69], s[36:37]
    v_pk_mul_f32 v[70:71], v[70:71], s[36:37]
    v_cvt_pk_bf16_f32 v40, v64, v65
    v_cvt_pk_bf16_f32 v41, v66, v67
    v_cvt_pk_bf16_f32 v42, v68, v69
    v_cvt_pk_bf16_f32 v43, v70, v71
    ds_write_b128 v30, v[40:43]
    buffer_load_dwordx4 v21, s[16:19], s45 offen offset:1024 nt lds
    buffer_load_dwordx4 v22, s[16:19], s45 offen offset:2048 nt lds
    s_waitcnt vmcnt(10)
    v_lshlrev_b32 v72, 16, v44
    v_and_b32 v73, 0xffff0000, v44
    v_lshlrev_b32 v74, 16, v45
    v_and_b32 v75, 0xffff0000, v45
    v_lshlrev_b32 v76, 16, v46
    v_and_b32 v77, 0xffff0000, v46
    v_lshlrev_b32 v78, 16, v47
    v_and_b32 v79, 0xffff0000, v47
    v_pk_mul_f32 v[72:73], v[72:73], s[36:37]
    v_pk_mul_f32 v[74:75], v[74:75], s[36:37]
    v_pk_mul_f32 v[76:77], v[76:77], s[36:37]
    v_pk_mul_f32 v[78:79], v[78:79], s[36:37]
    v_cvt_pk_bf16_f32 v44, v72, v73
    v_cvt_pk_bf16_f32 v45, v74, v75
    v_cvt_pk_bf16_f32 v46, v76, v77
    v_cvt_pk_bf16_f32 v47, v78, v79
    ds_write_b128 v30, v[44:47] offset:4096
    buffer_load_dwordx4 v23, s[16:19], s45 offen offset:3072 nt lds
    s_add_u32 m0, s33, 0x2000
    s_nop 0
    buffer_load_dwordx4 v24, s[20:23], s44 offen nt lds
    s_waitcnt vmcnt(10)
    v_lshlrev_b32 v64, 16, v48
    v_and_b32 v65, 0xffff0000, v48
    v_lshlrev_b32 v66, 16, v49
    v_and_b32 v67, 0xffff0000, v49
    v_lshlrev_b32 v68, 16, v50
    v_and_b32 v69, 0xffff0000, v50
    v_lshlrev_b32 v70, 16, v51
    v_and_b32 v71, 0xffff0000, v51
    v_pk_mul_f32 v[64:65], v[64:65], s[36:37]
    v_pk_mul_f32 v[66:67], v[66:67], s[36:37]
    v_pk_mul_f32 v[68:69], v[68:69], s[36:37]
    v_pk_mul_f32 v[70:71], v[70:71], s[36:37]
    v_cvt_pk_bf16_f32 v48, v64, v65
    v_cvt_pk_bf16_f32 v49, v66, v67
    v_cvt_pk_bf16_f32 v50, v68, v69
    v_cvt_pk_bf16_f32 v51, v70, v71
    ds_write_b128 v30, v[48:51] offset:40960
    buffer_load_dwordx4 v25, s[20:23], s44 offen offset:1024 nt lds
    buffer_load_dwordx4 v24, s[20:23], s44 offen offset:2048 nt lds
    s_waitcnt vmcnt(10)
    v_lshlrev_b32 v72, 16, v52
    v_and_b32 v73, 0xffff0000, v52
    v_lshlrev_b32 v74, 16, v53
    v_and_b32 v75, 0xffff0000, v53
    v_lshlrev_b32 v76, 16, v54
    v_and_b32 v77, 0xffff0000, v54
    v_lshlrev_b32 v78, 16, v55
    v_and_b32 v79, 0xffff0000, v55
    v_pk_mul_f32 v[72:73], v[72:73], s[36:37]
    v_pk_mul_f32 v[74:75], v[74:75], s[36:37]
    v_pk_mul_f32 v[76:77], v[76:77], s[36:37]
    v_pk_mul_f32 v[78:79], v[78:79], s[36:37]
    v_cvt_pk_bf16_f32 v52, v72, v73
    v_cvt_pk_bf16_f32 v53, v74, v75
    v_cvt_pk_bf16_f32 v54, v76, v77
    v_cvt_pk_bf16_f32 v55, v78, v79
    ds_write_b128 v30, v[52:55] offset:45056
    buffer_load_dwordx4 v25, s[20:23], s44 offen offset:3072 nt lds
    s_add_u32 m0, s33, 0x3000
    s_nop 0
    buffer_load_dwordx4 v24, s[20:23], s45 offen nt lds
    s_waitcnt vmcnt(10)
    v_lshlrev_b32 v64, 16, v56
    v_and_b32 v65, 0xffff0000, v56
    v_lshlrev_b32 v66, 16, v57
    v_and_b32 v67, 0xffff0000, v57
    v_lshlrev_b32 v68, 16, v58
    v_and_b32 v69, 0xffff0000, v58
    v_lshlrev_b32 v70, 16, v59
    v_and_b32 v71, 0xffff0000, v59
    v_pk_mul_f32 v[64:65], v[64:65], s[36:37]
    v_pk_mul_f32 v[66:67], v[66:67], s[36:37]
    v_pk_mul_f32 v[68:69], v[68:69], s[36:37]
    v_pk_mul_f32 v[70:71], v[70:71], s[36:37]
    v_cvt_pk_bf16_f32 v56, v64, v65
    v_cvt_pk_bf16_f32 v57, v66, v67
    v_cvt_pk_bf16_f32 v58, v68, v69
    v_cvt_pk_bf16_f32 v59, v70, v71
    ds_write_b128 v31, v[56:59]
    buffer_load_dwordx4 v25, s[20:23], s45 offen offset:1024 nt lds
    buffer_load_dwordx4 v24, s[20:23], s45 offen offset:2048 nt lds
    s_waitcnt vmcnt(10)
    v_lshlrev_b32 v72, 16, v60
    v_and_b32 v73, 0xffff0000, v60
    v_lshlrev_b32 v74, 16, v61
    v_and_b32 v75, 0xffff0000, v61
    v_lshlrev_b32 v76, 16, v62
    v_and_b32 v77, 0xffff0000, v62
    v_lshlrev_b32 v78, 16, v63
    v_and_b32 v79, 0xffff0000, v63
    v_pk_mul_f32 v[72:73], v[72:73], s[36:37]
    v_pk_mul_f32 v[74:75], v[74:75], s[36:37]
    v_pk_mul_f32 v[76:77], v[76:77], s[36:37]
    v_pk_mul_f32 v[78:79], v[78:79], s[36:37]
    v_cvt_pk_bf16_f32 v60, v72, v73
    v_cvt_pk_bf16_f32 v61, v74, v75
    v_cvt_pk_bf16_f32 v62, v76, v77
    v_cvt_pk_bf16_f32 v63, v78, v79
    ds_write_b128 v31, v[60:63] offset:4096
    buffer_load_dwordx4 v25, s[20:23], s45 offen offset:3072 nt lds
    ds_read_b128 a[144:147], v8
    ds_read_b128 a[148:151], v9
    ds_read_b128 a[152:155], v10
    ds_read_b128 a[156:159], v11
    s_cmp_lg_u32 s34, 0
    s_waitcnt lgkmcnt(4)
    s_barrier
    s_cbranch_scc1 L_fbmax
    ds_read_b128 v[232:235], v32
    ds_read_b128 v[236:239], v32 offset:64
    ds_read_b128 v[240:243], v32 offset:128
    ds_read_b128 v[244:247], v32 offset:192
    ds_read_b128 a[0:3], v80
    ds_read_b128 a[4:7], v81
    ds_read_b128 a[8:11], v82
    ds_read_b128 a[12:15], v83
    s_add_u32 m0, s33, 0x4000
    s_nop 0
    buffer_load_dwordx4 v20, s[16:19], s46 offen nt lds
    ds_read_b128 a[16:19], v80 offset:4096
    ds_read_b128 a[20:23], v81 offset:4096
    ds_read_b128 a[24:27], v82 offset:4096
    ds_read_b128 a[28:31], v83 offset:4096
    s_waitcnt lgkmcnt(11)
    v_xor_b32 v232, 0x80008000, v232
    v_xor_b32 v233, 0x80008000, v233
    v_xor_b32 v234, 0x80008000, v234
    v_xor_b32 v235, 0x80008000, v235
    s_waitcnt lgkmcnt(10)
    v_xor_b32 v236, 0x80008000, v236
    v_xor_b32 v237, 0x80008000, v237
    v_xor_b32 v238, 0x80008000, v238
    v_xor_b32 v239, 0x80008000, v239
    s_waitcnt lgkmcnt(9)
    v_xor_b32 v240, 0x80008000, v240
    v_xor_b32 v241, 0x80008000, v241
    v_xor_b32 v242, 0x80008000, v242
    v_xor_b32 v243, 0x80008000, v243
    s_waitcnt lgkmcnt(8)
    v_xor_b32 v244, 0x80008000, v244
    v_xor_b32 v245, 0x80008000, v245
    v_xor_b32 v246, 0x80008000, v246
    v_xor_b32 v247, 0x80008000, v247
    s_waitcnt lgkmcnt(7)
    v_mfma_f32_16x16x32_bf16 v[184:187], v[232:235], a[0:3], 0
    ds_read_b128 a[32:35], v80 offset:40960
    buffer_load_dwordx4 v21, s[16:19], s46 offen offset:1024 nt lds
    s_waitcnt lgkmcnt(7)
    v_mfma_f32_16x16x32_bf16 v[184:187], v[236:239], a[4:7], v[184:187]
    ds_read_b128 a[36:39], v81 offset:40960
    s_waitcnt lgkmcnt(7)
    v_mfma_f32_16x16x32_bf16 v[184:187], v[240:243], a[8:11], v[184:187]
    ds_read_b128 a[40:43], v82 offset:40960
    s_waitcnt lgkmcnt(7)
    v_mfma_f32_16x16x32_bf16 v[184:187], v[244:247], a[12:15], v[184:187]
    ds_read_b128 a[44:47], v83 offset:40960
    s_waitcnt lgkmcnt(7)
    v_mfma_f32_16x16x32_bf16 v[188:191], v[232:235], a[16:19], 0
    ds_read_b128 a[48:51], v80 offset:45056
    buffer_load_dwordx4 v22, s[16:19], s46 offen offset:2048 nt lds
    s_waitcnt lgkmcnt(7)
    v_mfma_f32_16x16x32_bf16 v[188:191], v[236:239], a[20:23], v[188:191]
    ds_read_b128 a[52:55], v81 offset:45056
    s_waitcnt lgkmcnt(7)
    v_mfma_f32_16x16x32_bf16 v[188:191], v[240:243], a[24:27], v[188:191]
    ds_read_b128 a[56:59], v82 offset:45056
    s_waitcnt lgkmcnt(7)
    v_mfma_f32_16x16x32_bf16 v[188:191], v[244:247], a[28:31], v[188:191]
    ds_read_b128 a[60:63], v83 offset:45056
    s_waitcnt lgkmcnt(7)
    v_mfma_f32_16x16x32_bf16 v[192:195], v[232:235], a[32:35], 0
    ds_read_b128 a[64:67], v84
    s_waitcnt lgkmcnt(7)
    v_mfma_f32_16x16x32_bf16 v[192:195], v[236:239], a[36:39], v[192:195]
    ds_read_b128 a[68:71], v85
    s_waitcnt lgkmcnt(7)
    v_mfma_f32_16x16x32_bf16 v[192:195], v[240:243], a[40:43], v[192:195]
    ds_read_b128 a[72:75], v86
    s_waitcnt lgkmcnt(7)
    v_mfma_f32_16x16x32_bf16 v[192:195], v[244:247], a[44:47], v[192:195]
    ds_read_b128 a[76:79], v87
    s_waitcnt lgkmcnt(7)
    v_mfma_f32_16x16x32_bf16 v[196:199], v[232:235], a[48:51], 0
    ds_read_b128 a[80:83], v84 offset:4096
    s_waitcnt lgkmcnt(7)
    v_mfma_f32_16x16x32_bf16 v[196:199], v[236:239], a[52:55], v[196:199]
    ds_read_b128 a[84:87], v85 offset:4096
    s_waitcnt lgkmcnt(7)
    v_mfma_f32_16x16x32_bf16 v[196:199], v[240:243], a[56:59], v[196:199]
    ds_read_b128 a[88:91], v86 offset:4096
    s_waitcnt lgkmcnt(7)
    v_mfma_f32_16x16x32_bf16 v[196:199], v[244:247], a[60:63], v[196:199]
    ds_read_b128 a[92:95], v87 offset:4096
    s_waitcnt lgkmcnt(7)
    v_mfma_f32_16x16x32_bf16 v[200:203], v[232:235], a[64:67], 0
    s_waitcnt vmcnt(11)
    ds_read_b128 a[160:163], v8 offset:4096
    s_waitcnt lgkmcnt(7)
    v_mfma_f32_16x16x32_bf16 v[200:203], v[236:239], a[68:71], v[200:203]
    ds_read_b128 a[164:167], v9 offset:4096
    s_waitcnt lgkmcnt(7)
    v_mfma_f32_16x16x32_bf16 v[200:203], v[240:243], a[72:75], v[200:203]
    ds_read_b128 a[168:171], v10 offset:4096
    s_waitcnt lgkmcnt(7)
    v_mfma_f32_16x16x32_bf16 v[200:203], v[244:247], a[76:79], v[200:203]
    ds_read_b128 a[172:175], v11 offset:4096
    s_waitcnt lgkmcnt(7)
    v_mfma_f32_16x16x32_bf16 v[204:207], v[232:235], a[80:83], 0
    s_waitcnt lgkmcnt(6)
    v_mfma_f32_16x16x32_bf16 v[204:207], v[236:239], a[84:87], v[204:207]
    s_waitcnt lgkmcnt(5)
    v_mfma_f32_16x16x32_bf16 v[204:207], v[240:243], a[88:91], v[204:207]
    s_waitcnt lgkmcnt(4)
    v_mfma_f32_16x16x32_bf16 v[204:207], v[244:247], a[92:95], v[204:207]
L_mx:
    v_mfma_f32_16x16x32_bf16 v[208:211], a[144:147], a[0:3], v[184:187]
    buffer_load_dwordx4 v23, s[16:19], s46 offen offset:3072 nt lds
    v_mfma_f32_16x16x32_bf16 v[208:211], a[148:151], a[4:7], v[208:211]
    s_add_u32 m0, s33, 0x5000
    v_mfma_f32_16x16x32_bf16 v[208:211], a[152:155], a[8:11], v[208:211]
    buffer_load_dwordx4 v20, s[16:19], s47 offen nt lds
    v_mfma_f32_16x16x32_bf16 v[208:211], a[156:159], a[12:15], v[208:211]
    buffer_load_dwordx4 v21, s[16:19], s47 offen offset:1024 nt lds
    s_waitcnt lgkmcnt(3)
    v_mfma_f32_16x16x32_bf16 v[212:215], a[160:163], a[0:3], v[184:187]
    buffer_load_dwordx4 v22, s[16:19], s47 offen offset:2048 nt lds
    s_waitcnt lgkmcnt(2)
    v_mfma_f32_16x16x32_bf16 v[212:215], a[164:167], a[4:7], v[212:215]
    buffer_load_dwordx4 v23, s[16:19], s47 offen offset:3072 nt lds
    s_waitcnt lgkmcnt(1)
    v_mfma_f32_16x16x32_bf16 v[212:215], a[168:171], a[8:11], v[212:215]
    s_add_u32 m0, s33, 0x6000
    s_waitcnt lgkmcnt(0)
    v_mfma_f32_16x16x32_bf16 v[212:215], a[172:175], a[12:15], v[212:215]
    buffer_load_dwordx4 v24, s[20:23], s46 offen nt lds
    v_exp_f32 v208, v208
    s_mov_b64 vcc, -1
    s_cmp_lg_u32 s43, 1
    s_cbranch_scc0 L_t2
    s_cmp_lg_u32 s43, 5
    s_cbranch_scc0 L_t5
    s_cmp_lg_u32 s43, 2
    s_cbranch_scc0 L_t3
    s_cmp_lg_u32 s43, 6
    s_cbranch_scc0 L_t6
    s_cmp_lg_u32 s43, 3
    s_cbranch_scc0 L_t4
    s_cmp_lg_u32 s43, 7
    s_cbranch_scc0 L_t7
    s_cmp_lg_u32 s43, 4
    s_cbranch_scc0 L_tE
    s_branch L_x1
.p2align 12
L_tr:
    s_cbranch_scc1 L_x2
L_x1:
    s_mov_b64 vcc, 0
    s_waitcnt vmcnt(9)
    ds_read_b64_tr_b16 a[184:185], v14 offset:8192
    ds_read_b64_tr_b16 a[186:187], v14 offset:12288
    buffer_load_dwordx4 v25, s[20:23], s46 offen offset:1024 nt lds
    buffer_load_dwordx4 v24, s[20:23], s46 offen offset:2048 nt lds
    v_exp_f32 v209, v209
    buffer_load_dwordx4 v25, s[20:23], s46 offen offset:3072 nt lds
    v_mov_b32 v236, 0
    v_mov_b32 v237, 0
    v_exp_f32 v210, v210
    s_barrier
    v_mov_b32 v238, 0
    v_mov_b32 v239, 0
    v_exp_f32 v211, v211
    v_cvt_pk_bf16_f32 v224, v208, v209
    v_cvt_pk_bf16_f32 v225, v210, v211
    v_exp_f32 v212, v212
    s_add_u32 m0, s33, 0x7000
    ds_read_b64_tr_b16 a[188:189], v15 offset:8192
    ds_read_b64_tr_b16 a[190:191], v15 offset:12288
    v_mfma_f32_16x16x32_bf16 v[216:219], a[144:147], a[16:19], v[188:191]
    v_exp_f32 v213, v213
    v_mfma_f32_16x16x32_bf16 v[216:219], a[148:151], a[20:23], v[216:219]
    ds_read_b64_tr_b16 a[192:193], v16 offset:8192
    ds_read_b64_tr_b16 a[194:195], v16 offset:12288
    v_mfma_f32_16x16x32_bf16 v[216:219], a[152:155], a[24:27], v[216:219]
    v_exp_f32 v214, v214
    v_mfma_f32_16x16x32_bf16 v[216:219], a[156:159], a[28:31], v[216:219]
    ds_read_b64_tr_b16 a[196:197], v17 offset:8192
    ds_read_b64_tr_b16 a[198:199], v17 offset:12288
    v_mfma_f32_16x16x32_bf16 v[220:223], a[160:163], a[16:19], v[188:191]
    v_exp_f32 v215, v215
    v_mfma_f32_16x16x32_bf16 v[220:223], a[164:167], a[20:23], v[220:223]
    v_cvt_pk_bf16_f32 v226, v212, v213
    v_cvt_pk_bf16_f32 v227, v214, v215
    v_mfma_f32_16x16x32_bf16 v[220:223], a[168:171], a[24:27], v[220:223]
    ds_read_b64_tr_b16 a[200:201], v18 offset:8192
    ds_read_b64_tr_b16 a[202:203], v18 offset:12288
    ds_read_b64_tr_b16 a[204:205], v19 offset:8192
    v_mfma_f32_16x16x32_bf16 v[220:223], a[172:175], a[28:31], v[220:223]
    ds_read_b64_tr_b16 a[206:207], v19 offset:12288
    v_exp_f32 v216, v216
    s_waitcnt lgkmcnt(4)
    v_mfma_f32_16x16x32_bf16 a[96:99], a[184:187], v[224:227], 0
    ds_read_b64_tr_b16 a[176:177], v12 offset:8192
    ds_read_b64_tr_b16 a[178:179], v12 offset:12288
    v_exp_f32 v217, v217
    v_mfma_f32_16x16x32_bf16 v[88:91], v[224:227], a[188:191], 0
    ds_read_b64_tr_b16 a[180:181], v13 offset:8192
    ds_read_b64_tr_b16 a[182:183], v13 offset:12288
    v_mfma_f32_16x16x32_bf16 v[92:95], v[224:227], a[192:195], 0
    v_exp_f32 v218, v218
    v_mfma_f32_16x16x32_bf16 v[96:99], v[224:227], a[196:199], 0
    s_waitcnt lgkmcnt(0)
    buffer_load_dwordx4 v24, s[20:23], s47 offen nt lds
    v_mfma_f32_16x16x32_bf16 v[100:103], v[224:227], a[200:203], 0
    v_exp_f32 v219, v219
    v_mfma_f32_16x16x32_bf16 a[100:103], a[204:207], v[224:227], 0
    v_cvt_pk_bf16_f32 v228, v216, v217
    v_cvt_pk_bf16_f32 v229, v218, v219
    v_mfma_f32_16x16x32_bf16 v[40:43], a[176:179], v[224:227], 0
    v_exp_f32 v220, v220
    v_mfma_f32_16x16x32_bf16 v[44:47], a[180:183], v[224:227], 0
    buffer_load_dwordx4 v25, s[20:23], s47 offen offset:1024 nt lds
    v_mfma_f32_16x16x32_bf16 v[208:211], a[144:147], a[32:35], v[192:195]
    v_exp_f32 v221, v221
    v_mfma_f32_16x16x32_bf16 v[208:211], a[148:151], a[36:39], v[208:211]
    buffer_load_dwordx4 v24, s[20:23], s47 offen offset:2048 nt lds
    v_mfma_f32_16x16x32_bf16 v[208:211], a[152:155], a[40:43], v[208:211]
    v_exp_f32 v222, v222
    v_mfma_f32_16x16x32_bf16 v[208:211], a[156:159], a[44:47], v[208:211]
    buffer_load_dwordx4 v25, s[20:23], s47 offen offset:3072 nt lds
    v_mfma_f32_16x16x32_bf16 v[212:215], a[160:163], a[32:35], v[192:195]
    v_exp_f32 v223, v223
    v_mfma_f32_16x16x32_bf16 v[212:215], a[164:167], a[36:39], v[212:215]
    v_cvt_pk_bf16_f32 v230, v220, v221
    v_cvt_pk_bf16_f32 v231, v222, v223
    v_mfma_f32_16x16x32_bf16 v[212:215], a[168:171], a[40:43], v[212:215]
    s_mov_b32 m0, s33
    v_mfma_f32_16x16x32_bf16 v[212:215], a[172:175], a[44:47], v[212:215]
    v_exp_f32 v208, v208
    v_smfmac_f32_16x16x64_bf16 v[236:239], a[240:243], v[224:231], v6
    v_mfma_f32_16x16x32_bf16 a[104:107], a[184:187], v[228:231], 0
    v_exp_f32 v209, v209
    v_mfma_f32_16x16x32_bf16 v[104:107], v[228:231], a[188:191], 0
    v_mov_b32 v244, 0
    v_mov_b32 v245, 0
    v_mfma_f32_16x16x32_bf16 v[108:111], v[228:231], a[192:195], 0
    v_exp_f32 v210, v210
    v_mfma_f32_16x16x32_bf16 v[112:115], v[228:231], a[196:199], 0
    v_mov_b32 v246, 0
    v_mov_b32 v247, 0
    v_mfma_f32_16x16x32_bf16 v[116:119], v[228:231], a[200:203], 0
    v_exp_f32 v211, v211
    v_mfma_f32_16x16x32_bf16 a[108:111], a[204:207], v[228:231], 0
    v_cvt_pk_bf16_f32 v224, v208, v209
    v_cvt_pk_bf16_f32 v225, v210, v211
    v_mfma_f32_16x16x32_bf16 v[48:51], a[176:179], v[228:231], 0
    v_exp_f32 v212, v212
    v_mfma_f32_16x16x32_bf16 v[52:55], a[180:183], v[228:231], 0
    buffer_load_dwordx4 v20, s[16:19], s48 offen nt lds
    v_mfma_f32_16x16x32_bf16 v[216:219], a[144:147], a[48:51], v[196:199]
    v_exp_f32 v213, v213
    v_mfma_f32_16x16x32_bf16 v[216:219], a[148:151], a[52:55], v[216:219]
    buffer_load_dwordx4 v21, s[16:19], s48 offen offset:1024 nt lds
    v_mfma_f32_16x16x32_bf16 v[216:219], a[152:155], a[56:59], v[216:219]
    v_exp_f32 v214, v214
    v_mfma_f32_16x16x32_bf16 v[216:219], a[156:159], a[60:63], v[216:219]
    buffer_load_dwordx4 v22, s[16:19], s48 offen offset:2048 nt lds
    v_mfma_f32_16x16x32_bf16 v[220:223], a[160:163], a[48:51], v[196:199]
    v_exp_f32 v215, v215
    v_mfma_f32_16x16x32_bf16 v[220:223], a[164:167], a[52:55], v[220:223]
    v_cvt_pk_bf16_f32 v226, v212, v213
    v_cvt_pk_bf16_f32 v227, v214, v215
    v_mfma_f32_16x16x32_bf16 v[220:223], a[168:171], a[56:59], v[220:223]
    v_mfma_f32_16x16x32_bf16 v[220:223], a[172:175], a[60:63], v[220:223]
    v_exp_f32 v216, v216
    v_mfma_f32_16x16x32_bf16 a[112:115], a[184:187], v[224:227], 0
    v_exp_f32 v217, v217
    v_mfma_f32_16x16x32_bf16 v[120:123], v[224:227], a[188:191], 0
    buffer_load_dwordx4 v23, s[16:19], s48 offen offset:3072 nt lds
    v_mfma_f32_16x16x32_bf16 v[124:127], v[224:227], a[192:195], 0
    v_exp_f32 v218, v218
    v_mfma_f32_16x16x32_bf16 v[128:131], v[224:227], a[196:199], 0
    s_add_u32 m0, s33, 0x1000
    v_mfma_f32_16x16x32_bf16 v[132:135], v[224:227], a[200:203], 0
    v_exp_f32 v219, v219
    v_mfma_f32_16x16x32_bf16 a[116:119], a[204:207], v[224:227], 0
    v_cvt_pk_bf16_f32 v228, v216, v217
    v_cvt_pk_bf16_f32 v229, v218, v219
    v_mfma_f32_16x16x32_bf16 v[56:59], a[176:179], v[224:227], 0
    v_exp_f32 v220, v220
    v_mfma_f32_16x16x32_bf16 v[60:63], a[180:183], v[224:227], 0
    buffer_load_dwordx4 v20, s[16:19], s49 offen nt lds
    v_mfma_f32_16x16x32_bf16 v[208:211], a[144:147], a[64:67], v[200:203]
    v_exp_f32 v221, v221
    v_mfma_f32_16x16x32_bf16 v[208:211], a[148:151], a[68:71], v[208:211]
    v_mfma_f32_16x16x32_bf16 v[208:211], a[152:155], a[72:75], v[208:211]
    v_exp_f32 v222, v222
    v_mfma_f32_16x16x32_bf16 v[208:211], a[156:159], a[76:79], v[208:211]
    buffer_load_dwordx4 v21, s[16:19], s49 offen offset:1024 nt lds
    v_mfma_f32_16x16x32_bf16 v[212:215], a[160:163], a[64:67], v[200:203]
    v_exp_f32 v223, v223
    v_mfma_f32_16x16x32_bf16 v[212:215], a[164:167], a[68:71], v[212:215]
    v_cvt_pk_bf16_f32 v230, v220, v221
    v_cvt_pk_bf16_f32 v231, v222, v223
    v_mfma_f32_16x16x32_bf16 v[212:215], a[168:171], a[72:75], v[212:215]
    v_mfma_f32_16x16x32_bf16 v[212:215], a[172:175], a[76:79], v[212:215]
    v_exp_f32 v208, v208
    v_smfmac_f32_16x16x64_bf16 v[244:247], a[240:243], v[224:231], v6
    v_mfma_f32_16x16x32_bf16 a[120:123], a[184:187], v[228:231], 0
    v_exp_f32 v209, v209
    v_mfma_f32_16x16x32_bf16 v[136:139], v[228:231], a[188:191], 0
    v_mov_b32 v252, 0
    v_mov_b32 v253, 0
    v_mfma_f32_16x16x32_bf16 v[140:143], v[228:231], a[192:195], 0
    v_exp_f32 v210, v210
    v_mfma_f32_16x16x32_bf16 v[144:147], v[228:231], a[196:199], 0
    v_mov_b32 v254, 0
    v_mov_b32 v255, 0
    v_mfma_f32_16x16x32_bf16 v[148:151], v[228:231], a[200:203], 0
    v_exp_f32 v211, v211
    v_mfma_f32_16x16x32_bf16 a[124:127], a[204:207], v[228:231], 0
    s_bfe_u32 s50, s41, 0x4000c
    v_cvt_pk_bf16_f32 v224, v208, v209
    v_cvt_pk_bf16_f32 v225, v210, v211
L_x2:
    v_mfma_f32_16x16x32_bf16 v[64:67], a[176:179], v[228:231], 0
    s_waitcnt vmcnt(14)
    v_exp_f32 v212, v212
    v_mfma_f32_16x16x32_bf16 v[68:71], a[180:183], v[228:231], 0
    buffer_load_dwordx4 v22, s[16:19], s49 offen offset:2048 nt lds
    v_mfma_f32_16x16x32_bf16 v[216:219], a[144:147], a[80:83], v[204:207]
    s_mul_i32 s50, s50, 0x2000
    v_exp_f32 v213, v213
    v_mfma_f32_16x16x32_bf16 v[216:219], a[148:151], a[84:87], v[216:219]
    s_add_u32 s50, s50, s44
    ds_read_b128 a[144:147], v8 offset:16384
    ds_read_b128 a[148:151], v9 offset:16384
    v_mfma_f32_16x16x32_bf16 v[216:219], a[152:155], a[88:91], v[216:219]
    s_and_b32 s50, s50, 0x1ffff
    v_exp_f32 v214, v214
    v_mfma_f32_16x16x32_bf16 v[216:219], a[156:159], a[92:95], v[216:219]
    s_add_u32 s51, s50, 0x1000
    ds_read_b128 a[152:155], v10 offset:16384
    ds_read_b128 a[156:159], v11 offset:16384
    v_mfma_f32_16x16x32_bf16 v[220:223], a[160:163], a[80:83], v[204:207]
    v_exp_f32 v215, v215
    v_mfma_f32_16x16x32_bf16 v[220:223], a[164:167], a[84:87], v[220:223]
    v_cvt_pk_bf16_f32 v226, v212, v213
    v_cvt_pk_bf16_f32 v227, v214, v215
    v_mfma_f32_16x16x32_bf16 v[220:223], a[168:171], a[88:91], v[220:223]
    ds_read_b128 a[160:163], v8 offset:20480
    ds_read_b128 a[164:167], v9 offset:20480
    v_mfma_f32_16x16x32_bf16 v[220:223], a[172:175], a[92:95], v[220:223]
    v_exp_f32 v216, v216
    v_mfma_f32_16x16x32_bf16 a[128:131], a[184:187], v[224:227], 0
    v_exp_f32 v217, v217
    v_mfma_f32_16x16x32_bf16 v[152:155], v[224:227], a[188:191], 0
    ds_read_b128 a[168:171], v10 offset:20480
    ds_read_b128 a[172:175], v11 offset:20480
    v_mfma_f32_16x16x32_bf16 v[156:159], v[224:227], a[192:195], 0
    v_exp_f32 v218, v218
    v_mfma_f32_16x16x32_bf16 v[160:163], v[224:227], a[196:199], 0
    buffer_load_dwordx4 v23, s[16:19], s49 offen offset:3072 nt lds
    v_mfma_f32_16x16x32_bf16 v[164:167], v[224:227], a[200:203], 0
    s_add_u32 m0, s33, 0x2000
    v_exp_f32 v219, v219
    v_mfma_f32_16x16x32_bf16 v[240:243], v[224:227], a[204:207], 0
    v_cvt_pk_bf16_f32 v228, v216, v217
    v_cvt_pk_bf16_f32 v229, v218, v219
    v_mfma_f32_16x16x32_bf16 v[72:75], a[176:179], v[224:227], 0
    v_exp_f32 v220, v220
    v_mfma_f32_16x16x32_bf16 v[76:79], a[180:183], v[224:227], 0
    s_waitcnt lgkmcnt(0)
    buffer_load_dwordx4 v24, s[20:23], s48 offen nt lds
    v_mfma_f32_16x16x32_bf16 v[208:211], a[144:147], a[0:3], v[184:187]
    v_exp_f32 v221, v221
    v_mfma_f32_16x16x32_bf16 v[208:211], a[148:151], a[4:7], v[208:211]
    buffer_load_dwordx4 v25, s[20:23], s48 offen offset:1024 nt lds
    v_mfma_f32_16x16x32_bf16 v[208:211], a[152:155], a[8:11], v[208:211]
    v_exp_f32 v222, v222
    v_mfma_f32_16x16x32_bf16 v[208:211], a[156:159], a[12:15], v[208:211]
    buffer_load_dwordx4 v24, s[20:23], s48 offen offset:2048 nt lds
    v_mfma_f32_16x16x32_bf16 v[212:215], a[160:163], a[0:3], v[184:187]
    v_exp_f32 v223, v223
    v_mfma_f32_16x16x32_bf16 v[212:215], a[164:167], a[4:7], v[212:215]
    v_cvt_pk_bf16_f32 v230, v220, v221
    v_cvt_pk_bf16_f32 v231, v222, v223
    v_mfma_f32_16x16x32_bf16 v[212:215], a[168:171], a[8:11], v[212:215]
    s_waitcnt vmcnt(11)
    buffer_load_dwordx4 v25, s[20:23], s48 offen offset:3072 nt lds
    v_mfma_f32_16x16x32_bf16 v[212:215], a[172:175], a[12:15], v[212:215]
    v_exp_f32 v208, v208
    v_smfmac_f32_16x16x64_bf16 v[252:255], a[240:243], v[224:231], v6
    s_add_u32 m0, s33, 0x3000
    v_mfma_f32_16x16x32_bf16 v[232:235], v[228:231], a[184:187], 0
    v_exp_f32 v209, v209
    v_mfma_f32_16x16x32_bf16 v[168:171], v[228:231], a[188:191], 0
    ds_read_b64_tr_b16 a[184:185], v14 offset:24576
    ds_read_b64_tr_b16 a[186:187], v14 offset:28672
    v_mfma_f32_16x16x32_bf16 v[172:175], v[228:231], a[192:195], 0
    v_exp_f32 v210, v210
    v_mfma_f32_16x16x32_bf16 v[176:179], v[228:231], a[196:199], 0
    ds_read_b64_tr_b16 a[188:189], v15 offset:24576
    ds_read_b64_tr_b16 a[190:191], v15 offset:28672
    v_mfma_f32_16x16x32_bf16 v[180:183], v[228:231], a[200:203], 0
    v_exp_f32 v211, v211
    v_mfma_f32_16x16x32_bf16 v[248:251], v[228:231], a[204:207], 0
    v_cvt_pk_bf16_f32 v224, v208, v209
    v_cvt_pk_bf16_f32 v225, v210, v211
    v_mfma_f32_16x16x32_bf16 v[80:83], a[176:179], v[228:231], 0
    v_exp_f32 v212, v212
    v_mfma_f32_16x16x32_bf16 v[84:87], a[180:183], v[228:231], 0
    ds_read_b64_tr_b16 a[192:193], v16 offset:24576
    ds_read_b64_tr_b16 a[194:195], v16 offset:28672
    v_mfma_f32_16x16x32_bf16 v[216:219], a[144:147], a[16:19], v[188:191]
    v_exp_f32 v213, v213
    v_mfma_f32_16x16x32_bf16 v[216:219], a[148:151], a[20:23], v[216:219]
    ds_read_b64_tr_b16 a[196:197], v17 offset:24576
    ds_read_b64_tr_b16 a[198:199], v17 offset:28672
    v_mfma_f32_16x16x32_bf16 v[216:219], a[152:155], a[24:27], v[216:219]
    v_exp_f32 v214, v214
    v_mfma_f32_16x16x32_bf16 v[216:219], a[156:159], a[28:31], v[216:219]
    ds_read_b64_tr_b16 a[200:201], v18 offset:24576
    ds_read_b64_tr_b16 a[202:203], v18 offset:28672
    v_mfma_f32_16x16x32_bf16 v[220:223], a[160:163], a[16:19], v[188:191]
    v_exp_f32 v215, v215
    v_mfma_f32_16x16x32_bf16 v[220:223], a[164:167], a[20:23], v[220:223]
    v_cvt_pk_bf16_f32 v226, v212, v213
    v_cvt_pk_bf16_f32 v227, v214, v215
    v_mfma_f32_16x16x32_bf16 v[220:223], a[168:171], a[24:27], v[220:223]
    ds_read_b64_tr_b16 a[204:205], v19 offset:24576
    ds_read_b64_tr_b16 a[206:207], v19 offset:28672
    ds_read_b64_tr_b16 a[176:177], v12 offset:24576
    v_mfma_f32_16x16x32_bf16 v[220:223], a[172:175], a[28:31], v[220:223]
    ds_read_b64_tr_b16 a[178:179], v12 offset:28672
    v_exp_f32 v216, v216
    s_waitcnt lgkmcnt(6)
    v_mfma_f32_16x16x32_bf16 a[96:99], a[184:187], v[224:227], a[96:99]
    v_exp_f32 v217, v217
    v_mfma_f32_16x16x32_bf16 v[88:91], v[224:227], a[188:191], v[88:91]
    ds_read_b64_tr_b16 a[180:181], v13 offset:24576
    ds_read_b64_tr_b16 a[182:183], v13 offset:28672
    v_mfma_f32_16x16x32_bf16 v[92:95], v[224:227], a[192:195], v[92:95]
    v_exp_f32 v218, v218
    v_mfma_f32_16x16x32_bf16 v[96:99], v[224:227], a[196:199], v[96:99]
    s_waitcnt lgkmcnt(0)
    buffer_load_dwordx4 v24, s[20:23], s49 offen nt lds
    v_mfma_f32_16x16x32_bf16 v[100:103], v[224:227], a[200:203], v[100:103]
    v_exp_f32 v219, v219
    v_mfma_f32_16x16x32_bf16 a[100:103], a[204:207], v[224:227], a[100:103]
    v_cvt_pk_bf16_f32 v228, v216, v217
    v_cvt_pk_bf16_f32 v229, v218, v219
    v_mfma_f32_16x16x32_bf16 v[40:43], a[176:179], v[224:227], v[40:43]
    v_exp_f32 v220, v220
    v_mfma_f32_16x16x32_bf16 v[44:47], a[180:183], v[224:227], v[44:47]
    buffer_load_dwordx4 v25, s[20:23], s49 offen offset:1024 nt lds
    v_mfma_f32_16x16x32_bf16 v[208:211], a[144:147], a[32:35], v[192:195]
    v_exp_f32 v221, v221
    v_mfma_f32_16x16x32_bf16 v[208:211], a[148:151], a[36:39], v[208:211]
    buffer_load_dwordx4 v24, s[20:23], s49 offen offset:2048 nt lds
    v_mfma_f32_16x16x32_bf16 v[208:211], a[152:155], a[40:43], v[208:211]
    v_exp_f32 v222, v222
    v_mfma_f32_16x16x32_bf16 v[208:211], a[156:159], a[44:47], v[208:211]
    buffer_load_dwordx4 v25, s[20:23], s49 offen offset:3072 nt lds
    v_mfma_f32_16x16x32_bf16 v[212:215], a[160:163], a[32:35], v[192:195]
    s_add_u32 m0, s33, 0x4000
    v_exp_f32 v223, v223
    v_mfma_f32_16x16x32_bf16 v[212:215], a[164:167], a[36:39], v[212:215]
    v_cvt_pk_bf16_f32 v230, v220, v221
    v_cvt_pk_bf16_f32 v231, v222, v223
    v_mfma_f32_16x16x32_bf16 v[212:215], a[168:171], a[40:43], v[212:215]
    buffer_load_dwordx4 v20, s[16:19], s50 offen nt lds
    v_mfma_f32_16x16x32_bf16 v[212:215], a[172:175], a[44:47], v[212:215]
    v_exp_f32 v208, v208
    v_smfmac_f32_16x16x64_bf16 v[236:239], a[240:243], v[224:231], v6
    v_mfma_f32_16x16x32_bf16 a[104:107], a[184:187], v[228:231], a[104:107]
    v_exp_f32 v209, v209
    v_mfma_f32_16x16x32_bf16 v[104:107], v[228:231], a[188:191], v[104:107]
    buffer_load_dwordx4 v21, s[16:19], s50 offen offset:1024 nt lds
    v_mfma_f32_16x16x32_bf16 v[108:111], v[228:231], a[192:195], v[108:111]
    v_exp_f32 v210, v210
    v_mfma_f32_16x16x32_bf16 v[112:115], v[228:231], a[196:199], v[112:115]
    buffer_load_dwordx4 v22, s[16:19], s50 offen offset:2048 nt lds
    v_mfma_f32_16x16x32_bf16 v[116:119], v[228:231], a[200:203], v[116:119]
    v_exp_f32 v211, v211
    v_mfma_f32_16x16x32_bf16 a[108:111], a[204:207], v[228:231], a[108:111]
    v_cvt_pk_bf16_f32 v224, v208, v209
    v_cvt_pk_bf16_f32 v225, v210, v211
    v_mfma_f32_16x16x32_bf16 v[48:51], a[176:179], v[228:231], v[48:51]
    v_exp_f32 v212, v212
    v_mfma_f32_16x16x32_bf16 v[52:55], a[180:183], v[228:231], v[52:55]
    buffer_load_dwordx4 v23, s[16:19], s50 offen offset:3072 nt lds
    v_mfma_f32_16x16x32_bf16 v[216:219], a[144:147], a[48:51], v[196:199]
    v_exp_f32 v213, v213
    v_mfma_f32_16x16x32_bf16 v[216:219], a[148:151], a[52:55], v[216:219]
    v_mfma_f32_16x16x32_bf16 v[216:219], a[152:155], a[56:59], v[216:219]
    v_exp_f32 v214, v214
    v_mfma_f32_16x16x32_bf16 v[216:219], a[156:159], a[60:63], v[216:219]
    v_mfma_f32_16x16x32_bf16 v[220:223], a[160:163], a[48:51], v[196:199]
    s_add_u32 m0, s33, 0x5000
    v_exp_f32 v215, v215
    v_mfma_f32_16x16x32_bf16 v[220:223], a[164:167], a[52:55], v[220:223]
    v_cvt_pk_bf16_f32 v226, v212, v213
    v_cvt_pk_bf16_f32 v227, v214, v215
    v_mfma_f32_16x16x32_bf16 v[220:223], a[168:171], a[56:59], v[220:223]
    buffer_load_dwordx4 v20, s[16:19], s51 offen nt lds
    v_mfma_f32_16x16x32_bf16 v[220:223], a[172:175], a[60:63], v[220:223]
    v_exp_f32 v216, v216
    v_mfma_f32_16x16x32_bf16 a[112:115], a[184:187], v[224:227], a[112:115]
    v_exp_f32 v217, v217
    v_mfma_f32_16x16x32_bf16 v[120:123], v[224:227], a[188:191], v[120:123]
    v_mfma_f32_16x16x32_bf16 v[124:127], v[224:227], a[192:195], v[124:127]
    v_exp_f32 v218, v218
    v_mfma_f32_16x16x32_bf16 v[128:131], v[224:227], a[196:199], v[128:131]
    buffer_load_dwordx4 v21, s[16:19], s51 offen offset:1024 nt lds
    v_mfma_f32_16x16x32_bf16 v[132:135], v[224:227], a[200:203], v[132:135]
    v_exp_f32 v219, v219
    v_mfma_f32_16x16x32_bf16 a[116:119], a[204:207], v[224:227], a[116:119]
    v_cvt_pk_bf16_f32 v228, v216, v217
    v_cvt_pk_bf16_f32 v229, v218, v219
    v_mfma_f32_16x16x32_bf16 v[56:59], a[176:179], v[224:227], v[56:59]
    v_exp_f32 v220, v220
    v_mfma_f32_16x16x32_bf16 v[60:63], a[180:183], v[224:227], v[60:63]
    v_mfma_f32_16x16x32_bf16 v[208:211], a[144:147], a[64:67], v[200:203]
    v_exp_f32 v221, v221
    v_mfma_f32_16x16x32_bf16 v[208:211], a[148:151], a[68:71], v[208:211]
    buffer_load_dwordx4 v22, s[16:19], s51 offen offset:2048 nt lds
    v_mfma_f32_16x16x32_bf16 v[208:211], a[152:155], a[72:75], v[208:211]
    v_exp_f32 v222, v222
    v_mfma_f32_16x16x32_bf16 v[208:211], a[156:159], a[76:79], v[208:211]
    v_mfma_f32_16x16x32_bf16 v[212:215], a[160:163], a[64:67], v[200:203]
    v_exp_f32 v223, v223
    v_mfma_f32_16x16x32_bf16 v[212:215], a[164:167], a[68:71], v[212:215]
    v_cvt_pk_bf16_f32 v230, v220, v221
    v_cvt_pk_bf16_f32 v231, v222, v223
    v_mfma_f32_16x16x32_bf16 v[212:215], a[168:171], a[72:75], v[212:215]
    buffer_load_dwordx4 v23, s[16:19], s51 offen offset:3072 nt lds
    v_mfma_f32_16x16x32_bf16 v[212:215], a[172:175], a[76:79], v[212:215]
    v_exp_f32 v208, v208
    v_smfmac_f32_16x16x64_bf16 v[244:247], a[240:243], v[224:231], v6
    v_mfma_f32_16x16x32_bf16 a[120:123], a[184:187], v[228:231], a[120:123]
    v_exp_f32 v209, v209
    v_mfma_f32_16x16x32_bf16 v[136:139], v[228:231], a[188:191], v[136:139]
    v_mfma_f32_16x16x32_bf16 v[140:143], v[228:231], a[192:195], v[140:143]
    s_add_u32 m0, s33, 0x6000
    v_exp_f32 v210, v210
    v_mfma_f32_16x16x32_bf16 v[144:147], v[228:231], a[196:199], v[144:147]
    buffer_load_dwordx4 v24, s[20:23], s50 offen nt lds
    v_mfma_f32_16x16x32_bf16 v[148:151], v[228:231], a[200:203], v[148:151]
    s_bfe_u32 s52, s41, 0x40010
    v_exp_f32 v211, v211
    v_mfma_f32_16x16x32_bf16 a[124:127], a[204:207], v[228:231], a[124:127]
    s_mul_i32 s52, s52, 0x2000
    v_cvt_pk_bf16_f32 v224, v208, v209
    v_cvt_pk_bf16_f32 v225, v210, v211
    v_mfma_f32_16x16x32_bf16 v[64:67], a[176:179], v[228:231], v[64:67]
    s_waitcnt vmcnt(17)
    v_exp_f32 v212, v212
    v_mfma_f32_16x16x32_bf16 v[68:71], a[180:183], v[228:231], v[68:71]
    s_add_u32 s52, s52, s44
    v_mfma_f32_16x16x32_bf16 v[216:219], a[144:147], a[80:83], v[204:207]
    s_and_b32 s52, s52, 0x1ffff
    v_exp_f32 v213, v213
    v_mfma_f32_16x16x32_bf16 v[216:219], a[148:151], a[84:87], v[216:219]
    s_add_u32 s53, s52, 0x1000
    ds_read_b128 a[144:147], v8
    ds_read_b128 a[148:151], v9
    v_mfma_f32_16x16x32_bf16 v[216:219], a[152:155], a[88:91], v[216:219]
    v_exp_f32 v214, v214
    v_mfma_f32_16x16x32_bf16 v[216:219], a[156:159], a[92:95], v[216:219]
    ds_read_b128 a[152:155], v10
    ds_read_b128 a[156:159], v11
    v_mfma_f32_16x16x32_bf16 v[220:223], a[160:163], a[80:83], v[204:207]
    v_exp_f32 v215, v215
    v_mfma_f32_16x16x32_bf16 v[220:223], a[164:167], a[84:87], v[220:223]
    v_cvt_pk_bf16_f32 v226, v212, v213
    v_cvt_pk_bf16_f32 v227, v214, v215
    v_mfma_f32_16x16x32_bf16 v[220:223], a[168:171], a[88:91], v[220:223]
    ds_read_b128 a[160:163], v8 offset:4096
    ds_read_b128 a[164:167], v9 offset:4096
    v_mfma_f32_16x16x32_bf16 v[220:223], a[172:175], a[92:95], v[220:223]
    v_exp_f32 v216, v216
    v_mfma_f32_16x16x32_bf16 a[128:131], a[184:187], v[224:227], a[128:131]
    v_exp_f32 v217, v217
    v_mfma_f32_16x16x32_bf16 v[152:155], v[224:227], a[188:191], v[152:155]
    ds_read_b128 a[168:171], v10 offset:4096
    ds_read_b128 a[172:175], v11 offset:4096
    v_mfma_f32_16x16x32_bf16 v[156:159], v[224:227], a[192:195], v[156:159]
    v_exp_f32 v218, v218
    v_mfma_f32_16x16x32_bf16 v[160:163], v[224:227], a[196:199], v[160:163]
    buffer_load_dwordx4 v25, s[20:23], s50 offen offset:1024 nt lds
    v_mfma_f32_16x16x32_bf16 v[164:167], v[224:227], a[200:203], v[164:167]
    v_exp_f32 v219, v219
    v_mfma_f32_16x16x32_bf16 v[240:243], v[224:227], a[204:207], v[240:243]
    v_cvt_pk_bf16_f32 v228, v216, v217
    v_cvt_pk_bf16_f32 v229, v218, v219
    v_mfma_f32_16x16x32_bf16 v[72:75], a[176:179], v[224:227], v[72:75]
    v_exp_f32 v220, v220
    v_mfma_f32_16x16x32_bf16 v[76:79], a[180:183], v[224:227], v[76:79]
    s_waitcnt lgkmcnt(0)
    buffer_load_dwordx4 v24, s[20:23], s50 offen offset:2048 nt lds
    v_mfma_f32_16x16x32_bf16 v[208:211], a[144:147], a[0:3], v[184:187]
    v_exp_f32 v221, v221
    v_mfma_f32_16x16x32_bf16 v[208:211], a[148:151], a[4:7], v[208:211]
    buffer_load_dwordx4 v25, s[20:23], s50 offen offset:3072 nt lds
    v_mfma_f32_16x16x32_bf16 v[208:211], a[152:155], a[8:11], v[208:211]
    s_add_u32 m0, s33, 0x7000
    v_exp_f32 v222, v222
    v_mfma_f32_16x16x32_bf16 v[208:211], a[156:159], a[12:15], v[208:211]
    buffer_load_dwordx4 v24, s[20:23], s51 offen nt lds
    v_mfma_f32_16x16x32_bf16 v[212:215], a[160:163], a[0:3], v[184:187]
    v_exp_f32 v223, v223
    v_mfma_f32_16x16x32_bf16 v[212:215], a[164:167], a[4:7], v[212:215]
    v_cvt_pk_bf16_f32 v230, v220, v221
    v_cvt_pk_bf16_f32 v231, v222, v223
    v_mfma_f32_16x16x32_bf16 v[212:215], a[168:171], a[8:11], v[212:215]
    s_waitcnt vmcnt(13)
    v_mfma_f32_16x16x32_bf16 v[212:215], a[172:175], a[12:15], v[212:215]
    v_exp_f32 v208, v208
    v_smfmac_f32_16x16x64_bf16 v[252:255], a[240:243], v[224:231], v6
    v_mfma_f32_16x16x32_bf16 v[232:235], v[228:231], a[184:187], v[232:235]
    v_exp_f32 v209, v209
    v_mfma_f32_16x16x32_bf16 v[168:171], v[228:231], a[188:191], v[168:171]
    ds_read_b64_tr_b16 a[184:185], v14 offset:8192
    ds_read_b64_tr_b16 a[186:187], v14 offset:12288
    v_mfma_f32_16x16x32_bf16 v[172:175], v[228:231], a[192:195], v[172:175]
    v_exp_f32 v210, v210
    v_mfma_f32_16x16x32_bf16 v[176:179], v[228:231], a[196:199], v[176:179]
    ds_read_b64_tr_b16 a[188:189], v15 offset:8192
    ds_read_b64_tr_b16 a[190:191], v15 offset:12288
    v_mfma_f32_16x16x32_bf16 v[180:183], v[228:231], a[200:203], v[180:183]
    v_exp_f32 v211, v211
    v_mfma_f32_16x16x32_bf16 v[248:251], v[228:231], a[204:207], v[248:251]
    v_cvt_pk_bf16_f32 v224, v208, v209
    v_cvt_pk_bf16_f32 v225, v210, v211
    v_mfma_f32_16x16x32_bf16 v[80:83], a[176:179], v[228:231], v[80:83]
    v_exp_f32 v212, v212
    v_mfma_f32_16x16x32_bf16 v[84:87], a[180:183], v[228:231], v[84:87]
    ds_read_b64_tr_b16 a[192:193], v16 offset:8192
    ds_read_b64_tr_b16 a[194:195], v16 offset:12288
    v_mfma_f32_16x16x32_bf16 v[216:219], a[144:147], a[16:19], v[188:191]
    v_exp_f32 v213, v213
    v_mfma_f32_16x16x32_bf16 v[216:219], a[148:151], a[20:23], v[216:219]
    ds_read_b64_tr_b16 a[196:197], v17 offset:8192
    ds_read_b64_tr_b16 a[198:199], v17 offset:12288
    v_mfma_f32_16x16x32_bf16 v[216:219], a[152:155], a[24:27], v[216:219]
    v_exp_f32 v214, v214
    v_mfma_f32_16x16x32_bf16 v[216:219], a[156:159], a[28:31], v[216:219]
    ds_read_b64_tr_b16 a[200:201], v18 offset:8192
    ds_read_b64_tr_b16 a[202:203], v18 offset:12288
    v_mfma_f32_16x16x32_bf16 v[220:223], a[160:163], a[16:19], v[188:191]
    v_exp_f32 v215, v215
    v_mfma_f32_16x16x32_bf16 v[220:223], a[164:167], a[20:23], v[220:223]
    v_cvt_pk_bf16_f32 v226, v212, v213
    v_cvt_pk_bf16_f32 v227, v214, v215
    v_mfma_f32_16x16x32_bf16 v[220:223], a[168:171], a[24:27], v[220:223]
    ds_read_b64_tr_b16 a[204:205], v19 offset:8192
    ds_read_b64_tr_b16 a[206:207], v19 offset:12288
    ds_read_b64_tr_b16 a[176:177], v12 offset:8192
    v_mfma_f32_16x16x32_bf16 v[220:223], a[172:175], a[28:31], v[220:223]
    ds_read_b64_tr_b16 a[178:179], v12 offset:12288
    v_exp_f32 v216, v216
    s_waitcnt lgkmcnt(6)
    v_mfma_f32_16x16x32_bf16 a[96:99], a[184:187], v[224:227], a[96:99]
    v_exp_f32 v217, v217
    v_mfma_f32_16x16x32_bf16 v[88:91], v[224:227], a[188:191], v[88:91]
    ds_read_b64_tr_b16 a[180:181], v13 offset:8192
    ds_read_b64_tr_b16 a[182:183], v13 offset:12288
    v_mfma_f32_16x16x32_bf16 v[92:95], v[224:227], a[192:195], v[92:95]
    v_exp_f32 v218, v218
    v_mfma_f32_16x16x32_bf16 v[96:99], v[224:227], a[196:199], v[96:99]
    s_waitcnt lgkmcnt(0)
    buffer_load_dwordx4 v25, s[20:23], s51 offen offset:1024 nt lds
    v_mfma_f32_16x16x32_bf16 v[100:103], v[224:227], a[200:203], v[100:103]
    v_exp_f32 v219, v219
    v_mfma_f32_16x16x32_bf16 a[100:103], a[204:207], v[224:227], a[100:103]
    v_cvt_pk_bf16_f32 v228, v216, v217
    v_cvt_pk_bf16_f32 v229, v218, v219
    v_mfma_f32_16x16x32_bf16 v[40:43], a[176:179], v[224:227], v[40:43]
    v_exp_f32 v220, v220
    v_mfma_f32_16x16x32_bf16 v[44:47], a[180:183], v[224:227], v[44:47]
    buffer_load_dwordx4 v24, s[20:23], s51 offen offset:2048 nt lds
    v_mfma_f32_16x16x32_bf16 v[208:211], a[144:147], a[32:35], v[192:195]
    v_exp_f32 v221, v221
    v_mfma_f32_16x16x32_bf16 v[208:211], a[148:151], a[36:39], v[208:211]
    buffer_load_dwordx4 v25, s[20:23], s51 offen offset:3072 nt lds
    v_mfma_f32_16x16x32_bf16 v[208:211], a[152:155], a[40:43], v[208:211]
    s_mov_b32 m0, s33
    v_exp_f32 v222, v222
    v_mfma_f32_16x16x32_bf16 v[208:211], a[156:159], a[44:47], v[208:211]
    buffer_load_dwordx4 v20, s[16:19], s52 offen lds
    v_mfma_f32_16x16x32_bf16 v[212:215], a[160:163], a[32:35], v[192:195]
    v_exp_f32 v223, v223
    v_mfma_f32_16x16x32_bf16 v[212:215], a[164:167], a[36:39], v[212:215]
    v_cvt_pk_bf16_f32 v230, v220, v221
    v_cvt_pk_bf16_f32 v231, v222, v223
    v_mfma_f32_16x16x32_bf16 v[212:215], a[168:171], a[40:43], v[212:215]
    buffer_load_dwordx4 v21, s[16:19], s52 offen offset:1024 lds
    v_mfma_f32_16x16x32_bf16 v[212:215], a[172:175], a[44:47], v[212:215]
    v_exp_f32 v208, v208
    v_smfmac_f32_16x16x64_bf16 v[236:239], a[240:243], v[224:231], v6
    v_mfma_f32_16x16x32_bf16 a[104:107], a[184:187], v[228:231], a[104:107]
    v_exp_f32 v209, v209
    v_mfma_f32_16x16x32_bf16 v[104:107], v[228:231], a[188:191], v[104:107]
    buffer_load_dwordx4 v22, s[16:19], s52 offen offset:2048 lds
    v_mfma_f32_16x16x32_bf16 v[108:111], v[228:231], a[192:195], v[108:111]
    v_exp_f32 v210, v210
    v_mfma_f32_16x16x32_bf16 v[112:115], v[228:231], a[196:199], v[112:115]
    buffer_load_dwordx4 v23, s[16:19], s52 offen offset:3072 lds
    v_mfma_f32_16x16x32_bf16 v[116:119], v[228:231], a[200:203], v[116:119]
    s_add_u32 m0, s33, 0x1000
    v_exp_f32 v211, v211
    v_mfma_f32_16x16x32_bf16 a[108:111], a[204:207], v[228:231], a[108:111]
    v_cvt_pk_bf16_f32 v224, v208, v209
    v_cvt_pk_bf16_f32 v225, v210, v211
    v_mfma_f32_16x16x32_bf16 v[48:51], a[176:179], v[228:231], v[48:51]
    v_exp_f32 v212, v212
    v_mfma_f32_16x16x32_bf16 v[52:55], a[180:183], v[228:231], v[52:55]
    buffer_load_dwordx4 v20, s[16:19], s53 offen lds
    v_mfma_f32_16x16x32_bf16 v[216:219], a[144:147], a[48:51], v[196:199]
    v_exp_f32 v213, v213
    v_mfma_f32_16x16x32_bf16 v[216:219], a[148:151], a[52:55], v[216:219]
    buffer_load_dwordx4 v21, s[16:19], s53 offen offset:1024 lds
    v_mfma_f32_16x16x32_bf16 v[216:219], a[152:155], a[56:59], v[216:219]
    v_exp_f32 v214, v214
    v_mfma_f32_16x16x32_bf16 v[216:219], a[156:159], a[60:63], v[216:219]
    buffer_load_dwordx4 v22, s[16:19], s53 offen offset:2048 lds
    v_mfma_f32_16x16x32_bf16 v[220:223], a[160:163], a[48:51], v[196:199]
    v_exp_f32 v215, v215
    v_mfma_f32_16x16x32_bf16 v[220:223], a[164:167], a[52:55], v[220:223]
    v_cvt_pk_bf16_f32 v226, v212, v213
    v_cvt_pk_bf16_f32 v227, v214, v215
    v_mfma_f32_16x16x32_bf16 v[220:223], a[168:171], a[56:59], v[220:223]
    buffer_load_dwordx4 v23, s[16:19], s53 offen offset:3072 lds
    v_mfma_f32_16x16x32_bf16 v[220:223], a[172:175], a[60:63], v[220:223]
    v_exp_f32 v216, v216
    v_mfma_f32_16x16x32_bf16 a[112:115], a[184:187], v[224:227], a[112:115]
    v_exp_f32 v217, v217
    v_mfma_f32_16x16x32_bf16 v[120:123], v[224:227], a[188:191], v[120:123]
    v_mfma_f32_16x16x32_bf16 v[124:127], v[224:227], a[192:195], v[124:127]
    v_exp_f32 v218, v218
    v_mfma_f32_16x16x32_bf16 v[128:131], v[224:227], a[196:199], v[128:131]
    v_mfma_f32_16x16x32_bf16 v[132:135], v[224:227], a[200:203], v[132:135]
    v_exp_f32 v219, v219
    v_mfma_f32_16x16x32_bf16 a[116:119], a[204:207], v[224:227], a[116:119]
    v_cvt_pk_bf16_f32 v228, v216, v217
    v_cvt_pk_bf16_f32 v229, v218, v219
    v_mfma_f32_16x16x32_bf16 v[56:59], a[176:179], v[224:227], v[56:59]
L_t2:
    s_cbranch_vccnz L_tr
    v_exp_f32 v220, v220
    v_mfma_f32_16x16x32_bf16 v[60:63], a[180:183], v[224:227], v[60:63]
    v_mfma_f32_16x16x32_bf16 v[208:211], a[144:147], a[64:67], v[200:203]
    v_exp_f32 v221, v221
    v_mfma_f32_16x16x32_bf16 v[208:211], a[148:151], a[68:71], v[208:211]
    v_mfma_f32_16x16x32_bf16 v[208:211], a[152:155], a[72:75], v[208:211]
    v_exp_f32 v222, v222
    v_mfma_f32_16x16x32_bf16 v[208:211], a[156:159], a[76:79], v[208:211]
    v_mfma_f32_16x16x32_bf16 v[212:215], a[160:163], a[64:67], v[200:203]
    v_exp_f32 v223, v223
    v_mfma_f32_16x16x32_bf16 v[212:215], a[164:167], a[68:71], v[212:215]
    v_cvt_pk_bf16_f32 v230, v220, v221
    v_cvt_pk_bf16_f32 v231, v222, v223
    v_mfma_f32_16x16x32_bf16 v[212:215], a[168:171], a[72:75], v[212:215]
    v_mfma_f32_16x16x32_bf16 v[212:215], a[172:175], a[76:79], v[212:215]
    v_exp_f32 v208, v208
    v_smfmac_f32_16x16x64_bf16 v[244:247], a[240:243], v[224:231], v6
    v_mfma_f32_16x16x32_bf16 a[120:123], a[184:187], v[228:231], a[120:123]
    v_exp_f32 v209, v209
    v_mfma_f32_16x16x32_bf16 v[136:139], v[228:231], a[188:191], v[136:139]
    v_mfma_f32_16x16x32_bf16 v[140:143], v[228:231], a[192:195], v[140:143]
    v_exp_f32 v210, v210
    v_mfma_f32_16x16x32_bf16 v[144:147], v[228:231], a[196:199], v[144:147]
    v_mfma_f32_16x16x32_bf16 v[148:151], v[228:231], a[200:203], v[148:151]
    v_exp_f32 v211, v211
    v_mfma_f32_16x16x32_bf16 a[124:127], a[204:207], v[228:231], a[124:127]
    v_cvt_pk_bf16_f32 v224, v208, v209
    v_cvt_pk_bf16_f32 v225, v210, v211
    v_mfma_f32_16x16x32_bf16 v[64:67], a[176:179], v[228:231], v[64:67]
    s_waitcnt vmcnt(16)
    v_exp_f32 v212, v212
    v_mfma_f32_16x16x32_bf16 v[68:71], a[180:183], v[228:231], v[68:71]
    v_mfma_f32_16x16x32_bf16 v[216:219], a[144:147], a[80:83], v[204:207]
    v_exp_f32 v213, v213
    v_mfma_f32_16x16x32_bf16 v[216:219], a[148:151], a[84:87], v[216:219]
    ds_read_b128 a[144:147], v8 offset:16384
    ds_read_b128 a[148:151], v9 offset:16384
    v_mfma_f32_16x16x32_bf16 v[216:219], a[152:155], a[88:91], v[216:219]
    v_exp_f32 v214, v214
    v_mfma_f32_16x16x32_bf16 v[216:219], a[156:159], a[92:95], v[216:219]
    ds_read_b128 a[152:155], v10 offset:16384
    ds_read_b128 a[156:159], v11 offset:16384
    v_mfma_f32_16x16x32_bf16 v[220:223], a[160:163], a[80:83], v[204:207]
    v_exp_f32 v215, v215
    v_mfma_f32_16x16x32_bf16 v[220:223], a[164:167], a[84:87], v[220:223]
    v_cvt_pk_bf16_f32 v226, v212, v213
    v_cvt_pk_bf16_f32 v227, v214, v215
    v_mfma_f32_16x16x32_bf16 v[220:223], a[168:171], a[88:91], v[220:223]
    ds_read_b128 a[160:163], v8 offset:20480
    ds_read_b128 a[164:167], v9 offset:20480
    v_mfma_f32_16x16x32_bf16 v[220:223], a[172:175], a[92:95], v[220:223]
    v_exp_f32 v216, v216
    v_mfma_f32_16x16x32_bf16 a[128:131], a[184:187], v[224:227], a[128:131]
    s_add_u32 m0, s33, 0x2000
    v_exp_f32 v217, v217
    v_mfma_f32_16x16x32_bf16 v[152:155], v[224:227], a[188:191], v[152:155]
    ds_read_b128 a[168:171], v10 offset:20480
    ds_read_b128 a[172:175], v11 offset:20480
    v_mfma_f32_16x16x32_bf16 v[156:159], v[224:227], a[192:195], v[156:159]
    v_exp_f32 v218, v218
    v_mfma_f32_16x16x32_bf16 v[160:163], v[224:227], a[196:199], v[160:163]
    buffer_load_dwordx4 v24, s[20:23], s52 offen lds
    v_mfma_f32_16x16x32_bf16 v[164:167], v[224:227], a[200:203], v[164:167]
    v_exp_f32 v219, v219
    v_mfma_f32_16x16x32_bf16 v[240:243], v[224:227], a[204:207], v[240:243]
    v_cvt_pk_bf16_f32 v228, v216, v217
    v_cvt_pk_bf16_f32 v229, v218, v219
    v_mfma_f32_16x16x32_bf16 v[72:75], a[176:179], v[224:227], v[72:75]
    v_exp_f32 v220, v220
    v_mfma_f32_16x16x32_bf16 v[76:79], a[180:183], v[224:227], v[76:79]
    s_waitcnt lgkmcnt(0)
    buffer_load_dwordx4 v25, s[20:23], s52 offen offset:1024 lds
    v_mfma_f32_16x16x32_bf16 v[208:211], a[144:147], a[0:3], v[184:187]
    v_exp_f32 v221, v221
    v_mfma_f32_16x16x32_bf16 v[208:211], a[148:151], a[4:7], v[208:211]
    buffer_load_dwordx4 v24, s[20:23], s52 offen offset:2048 lds
    v_mfma_f32_16x16x32_bf16 v[208:211], a[152:155], a[8:11], v[208:211]
    s_bfe_u32 s54, s41, 0x40014
    v_exp_f32 v222, v222
    v_mfma_f32_16x16x32_bf16 v[208:211], a[156:159], a[12:15], v[208:211]
    buffer_load_dwordx4 v25, s[20:23], s52 offen offset:3072 lds
    v_mfma_f32_16x16x32_bf16 v[212:215], a[160:163], a[0:3], v[184:187]
    s_mul_i32 s54, s54, 0x2000
    v_exp_f32 v223, v223
    v_mfma_f32_16x16x32_bf16 v[212:215], a[164:167], a[4:7], v[212:215]
    s_add_u32 s54, s54, s44
    v_cvt_pk_bf16_f32 v230, v220, v221
    v_cvt_pk_bf16_f32 v231, v222, v223
    v_mfma_f32_16x16x32_bf16 v[212:215], a[168:171], a[8:11], v[212:215]
    s_waitcnt vmcnt(12)
    v_mfma_f32_16x16x32_bf16 v[212:215], a[172:175], a[12:15], v[212:215]
    s_add_u32 m0, s33, 0x3000
    v_exp_f32 v208, v208
    v_smfmac_f32_16x16x64_bf16 v[252:255], a[240:243], v[224:231], v6
    buffer_load_dwordx4 v24, s[20:23], s53 offen lds
    v_mfma_f32_16x16x32_bf16 v[232:235], v[228:231], a[184:187], v[232:235]
    s_and_b32 s54, s54, 0x1ffff
    v_exp_f32 v209, v209
    v_mfma_f32_16x16x32_bf16 v[168:171], v[228:231], a[188:191], v[168:171]
    s_add_u32 s55, s54, 0x1000
    ds_read_b64_tr_b16 a[184:185], v14 offset:24576
    ds_read_b64_tr_b16 a[186:187], v14 offset:28672
    v_mfma_f32_16x16x32_bf16 v[172:175], v[228:231], a[192:195], v[172:175]
    v_exp_f32 v210, v210
    v_mfma_f32_16x16x32_bf16 v[176:179], v[228:231], a[196:199], v[176:179]
    ds_read_b64_tr_b16 a[188:189], v15 offset:24576
    ds_read_b64_tr_b16 a[190:191], v15 offset:28672
    buffer_load_dwordx4 v25, s[20:23], s53 offen offset:1024 lds
    v_mfma_f32_16x16x32_bf16 v[180:183], v[228:231], a[200:203], v[180:183]
    v_exp_f32 v211, v211
    v_mfma_f32_16x16x32_bf16 v[248:251], v[228:231], a[204:207], v[248:251]
    v_cvt_pk_bf16_f32 v224, v208, v209
    v_cvt_pk_bf16_f32 v225, v210, v211
    v_mfma_f32_16x16x32_bf16 v[80:83], a[176:179], v[228:231], v[80:83]
    v_exp_f32 v212, v212
    v_mfma_f32_16x16x32_bf16 v[84:87], a[180:183], v[228:231], v[84:87]
    ds_read_b64_tr_b16 a[192:193], v16 offset:24576
    ds_read_b64_tr_b16 a[194:195], v16 offset:28672
    v_mfma_f32_16x16x32_bf16 v[216:219], a[144:147], a[16:19], v[188:191]
    v_exp_f32 v213, v213
    v_mfma_f32_16x16x32_bf16 v[216:219], a[148:151], a[20:23], v[216:219]
    ds_read_b64_tr_b16 a[196:197], v17 offset:24576
    ds_read_b64_tr_b16 a[198:199], v17 offset:28672
    v_mfma_f32_16x16x32_bf16 v[216:219], a[152:155], a[24:27], v[216:219]
    v_exp_f32 v214, v214
    v_mfma_f32_16x16x32_bf16 v[216:219], a[156:159], a[28:31], v[216:219]
    ds_read_b64_tr_b16 a[200:201], v18 offset:24576
    ds_read_b64_tr_b16 a[202:203], v18 offset:28672
    v_mfma_f32_16x16x32_bf16 v[220:223], a[160:163], a[16:19], v[188:191]
    v_exp_f32 v215, v215
    v_mfma_f32_16x16x32_bf16 v[220:223], a[164:167], a[20:23], v[220:223]
    v_cvt_pk_bf16_f32 v226, v212, v213
    v_cvt_pk_bf16_f32 v227, v214, v215
    v_mfma_f32_16x16x32_bf16 v[220:223], a[168:171], a[24:27], v[220:223]
    ds_read_b64_tr_b16 a[204:205], v19 offset:24576
    ds_read_b64_tr_b16 a[206:207], v19 offset:28672
    ds_read_b64_tr_b16 a[176:177], v12 offset:24576
    v_mfma_f32_16x16x32_bf16 v[220:223], a[172:175], a[28:31], v[220:223]
    ds_read_b64_tr_b16 a[178:179], v12 offset:28672
    v_exp_f32 v216, v216
    s_waitcnt lgkmcnt(6)
    v_mfma_f32_16x16x32_bf16 a[96:99], a[184:187], v[224:227], a[96:99]
    v_exp_f32 v217, v217
    v_mfma_f32_16x16x32_bf16 v[88:91], v[224:227], a[188:191], v[88:91]
    ds_read_b64_tr_b16 a[180:181], v13 offset:24576
    ds_read_b64_tr_b16 a[182:183], v13 offset:28672
    v_mfma_f32_16x16x32_bf16 v[92:95], v[224:227], a[192:195], v[92:95]
    v_exp_f32 v218, v218
    v_mfma_f32_16x16x32_bf16 v[96:99], v[224:227], a[196:199], v[96:99]
    s_waitcnt lgkmcnt(0)
    buffer_load_dwordx4 v24, s[20:23], s53 offen offset:2048 lds
    v_mfma_f32_16x16x32_bf16 v[100:103], v[224:227], a[200:203], v[100:103]
    v_exp_f32 v219, v219
    v_mfma_f32_16x16x32_bf16 a[100:103], a[204:207], v[224:227], a[100:103]
    v_cvt_pk_bf16_f32 v228, v216, v217
    v_cvt_pk_bf16_f32 v229, v218, v219
    v_mfma_f32_16x16x32_bf16 v[40:43], a[176:179], v[224:227], v[40:43]
    v_exp_f32 v220, v220
    v_mfma_f32_16x16x32_bf16 v[44:47], a[180:183], v[224:227], v[44:47]
    buffer_load_dwordx4 v25, s[20:23], s53 offen offset:3072 lds
    v_mfma_f32_16x16x32_bf16 v[208:211], a[144:147], a[32:35], v[192:195]
    v_exp_f32 v221, v221
    v_mfma_f32_16x16x32_bf16 v[208:211], a[148:151], a[36:39], v[208:211]
    v_mfma_f32_16x16x32_bf16 v[208:211], a[152:155], a[40:43], v[208:211]
    v_exp_f32 v222, v222
    v_mfma_f32_16x16x32_bf16 v[208:211], a[156:159], a[44:47], v[208:211]
    v_mfma_f32_16x16x32_bf16 v[212:215], a[160:163], a[32:35], v[192:195]
    v_exp_f32 v223, v223
    v_mfma_f32_16x16x32_bf16 v[212:215], a[164:167], a[36:39], v[212:215]
    v_cvt_pk_bf16_f32 v230, v220, v221
    v_cvt_pk_bf16_f32 v231, v222, v223
    v_mfma_f32_16x16x32_bf16 v[212:215], a[168:171], a[40:43], v[212:215]
    v_mfma_f32_16x16x32_bf16 v[212:215], a[172:175], a[44:47], v[212:215]
    v_exp_f32 v208, v208
    v_smfmac_f32_16x16x64_bf16 v[236:239], a[240:243], v[224:231], v6
    v_mfma_f32_16x16x32_bf16 a[104:107], a[184:187], v[228:231], a[104:107]
    v_exp_f32 v209, v209
    v_mfma_f32_16x16x32_bf16 v[104:107], v[228:231], a[188:191], v[104:107]
    v_mfma_f32_16x16x32_bf16 v[108:111], v[228:231], a[192:195], v[108:111]
    v_exp_f32 v210, v210
    v_mfma_f32_16x16x32_bf16 v[112:115], v[228:231], a[196:199], v[112:115]
    v_mfma_f32_16x16x32_bf16 v[116:119], v[228:231], a[200:203], v[116:119]
    v_exp_f32 v211, v211
    v_mfma_f32_16x16x32_bf16 a[108:111], a[204:207], v[228:231], a[108:111]
    v_cvt_pk_bf16_f32 v224, v208, v209
    v_cvt_pk_bf16_f32 v225, v210, v211
    v_mfma_f32_16x16x32_bf16 v[48:51], a[176:179], v[228:231], v[48:51]
    v_exp_f32 v212, v212
    v_mfma_f32_16x16x32_bf16 v[52:55], a[180:183], v[228:231], v[52:55]
    v_mfma_f32_16x16x32_bf16 v[216:219], a[144:147], a[48:51], v[196:199]
    v_exp_f32 v213, v213
    v_mfma_f32_16x16x32_bf16 v[216:219], a[148:151], a[52:55], v[216:219]
    v_mfma_f32_16x16x32_bf16 v[216:219], a[152:155], a[56:59], v[216:219]
    v_exp_f32 v214, v214
    v_mfma_f32_16x16x32_bf16 v[216:219], a[156:159], a[60:63], v[216:219]
    v_mfma_f32_16x16x32_bf16 v[220:223], a[160:163], a[48:51], v[196:199]
    v_exp_f32 v215, v215
    v_mfma_f32_16x16x32_bf16 v[220:223], a[164:167], a[52:55], v[220:223]
    v_cvt_pk_bf16_f32 v226, v212, v213
    v_cvt_pk_bf16_f32 v227, v214, v215
    v_mfma_f32_16x16x32_bf16 v[220:223], a[168:171], a[56:59], v[220:223]
    v_mfma_f32_16x16x32_bf16 v[220:223], a[172:175], a[60:63], v[220:223]
    v_exp_f32 v216, v216
    v_mfma_f32_16x16x32_bf16 a[112:115], a[184:187], v[224:227], a[112:115]
    s_add_u32 m0, s33, 0x4000
    v_exp_f32 v217, v217
    v_mfma_f32_16x16x32_bf16 v[120:123], v[224:227], a[188:191], v[120:123]
    buffer_load_dwordx4 v20, s[16:19], s54 offen lds
    v_mfma_f32_16x16x32_bf16 v[124:127], v[224:227], a[192:195], v[124:127]
    v_exp_f32 v218, v218
    v_mfma_f32_16x16x32_bf16 v[128:131], v[224:227], a[196:199], v[128:131]
    buffer_load_dwordx4 v21, s[16:19], s54 offen offset:1024 lds
    v_mfma_f32_16x16x32_bf16 v[132:135], v[224:227], a[200:203], v[132:135]
    v_exp_f32 v219, v219
    v_mfma_f32_16x16x32_bf16 a[116:119], a[204:207], v[224:227], a[116:119]
    v_cvt_pk_bf16_f32 v228, v216, v217
    v_cvt_pk_bf16_f32 v229, v218, v219
    v_mfma_f32_16x16x32_bf16 v[56:59], a[176:179], v[224:227], v[56:59]
    v_exp_f32 v220, v220
    v_mfma_f32_16x16x32_bf16 v[60:63], a[180:183], v[224:227], v[60:63]
    buffer_load_dwordx4 v22, s[16:19], s54 offen offset:2048 lds
    v_mfma_f32_16x16x32_bf16 v[208:211], a[144:147], a[64:67], v[200:203]
    v_exp_f32 v221, v221
    v_mfma_f32_16x16x32_bf16 v[208:211], a[148:151], a[68:71], v[208:211]
    v_mfma_f32_16x16x32_bf16 v[208:211], a[152:155], a[72:75], v[208:211]
    v_exp_f32 v222, v222
    v_mfma_f32_16x16x32_bf16 v[208:211], a[156:159], a[76:79], v[208:211]
    buffer_load_dwordx4 v23, s[16:19], s54 offen offset:3072 lds
    v_mfma_f32_16x16x32_bf16 v[212:215], a[160:163], a[64:67], v[200:203]
    v_exp_f32 v223, v223
    v_mfma_f32_16x16x32_bf16 v[212:215], a[164:167], a[68:71], v[212:215]
    v_cvt_pk_bf16_f32 v230, v220, v221
    v_cvt_pk_bf16_f32 v231, v222, v223
    v_mfma_f32_16x16x32_bf16 v[212:215], a[168:171], a[72:75], v[212:215]
    v_mfma_f32_16x16x32_bf16 v[212:215], a[172:175], a[76:79], v[212:215]
    s_add_u32 m0, s33, 0x5000
    v_exp_f32 v208, v208
    v_smfmac_f32_16x16x64_bf16 v[244:247], a[240:243], v[224:231], v6
    v_mfma_f32_16x16x32_bf16 a[120:123], a[184:187], v[228:231], a[120:123]
    s_bfe_u32 s56, s41, 0x40018
    v_exp_f32 v209, v209
    v_mfma_f32_16x16x32_bf16 v[136:139], v[228:231], a[188:191], v[136:139]
    buffer_load_dwordx4 v20, s[16:19], s55 offen lds
    v_mfma_f32_16x16x32_bf16 v[140:143], v[228:231], a[192:195], v[140:143]
    s_mul_i32 s56, s56, 0x2000
    v_exp_f32 v210, v210
    v_mfma_f32_16x16x32_bf16 v[144:147], v[228:231], a[196:199], v[144:147]
    buffer_load_dwordx4 v21, s[16:19], s55 offen offset:1024 lds
    v_mfma_f32_16x16x32_bf16 v[148:151], v[228:231], a[200:203], v[148:151]
    s_add_u32 s56, s56, s44
    v_exp_f32 v211, v211
    v_mfma_f32_16x16x32_bf16 a[124:127], a[204:207], v[228:231], a[124:127]
    s_and_b32 s56, s56, 0x1ffff
    v_cvt_pk_bf16_f32 v224, v208, v209
    v_cvt_pk_bf16_f32 v225, v210, v211
    v_mfma_f32_16x16x32_bf16 v[64:67], a[176:179], v[228:231], v[64:67]
    s_waitcnt vmcnt(14)
    v_exp_f32 v212, v212
    v_mfma_f32_16x16x32_bf16 v[68:71], a[180:183], v[228:231], v[68:71]
    buffer_load_dwordx4 v22, s[16:19], s55 offen offset:2048 lds
    v_mfma_f32_16x16x32_bf16 v[216:219], a[144:147], a[80:83], v[204:207]
    s_add_u32 s57, s56, 0x1000
    v_exp_f32 v213, v213
    v_mfma_f32_16x16x32_bf16 v[216:219], a[148:151], a[84:87], v[216:219]
    ds_read_b128 a[144:147], v8
    ds_read_b128 a[148:151], v9
    v_mfma_f32_16x16x32_bf16 v[216:219], a[152:155], a[88:91], v[216:219]
    v_exp_f32 v214, v214
    v_mfma_f32_16x16x32_bf16 v[216:219], a[156:159], a[92:95], v[216:219]
    ds_read_b128 a[152:155], v10
    ds_read_b128 a[156:159], v11
    v_mfma_f32_16x16x32_bf16 v[220:223], a[160:163], a[80:83], v[204:207]
    v_exp_f32 v215, v215
    v_mfma_f32_16x16x32_bf16 v[220:223], a[164:167], a[84:87], v[220:223]
    v_cvt_pk_bf16_f32 v226, v212, v213
    v_cvt_pk_bf16_f32 v227, v214, v215
    v_mfma_f32_16x16x32_bf16 v[220:223], a[168:171], a[88:91], v[220:223]
    ds_read_b128 a[160:163], v8 offset:4096
    ds_read_b128 a[164:167], v9 offset:4096
    v_mfma_f32_16x16x32_bf16 v[220:223], a[172:175], a[92:95], v[220:223]
    v_exp_f32 v216, v216
    v_mfma_f32_16x16x32_bf16 a[128:131], a[184:187], v[224:227], a[128:131]
    v_exp_f32 v217, v217
    v_mfma_f32_16x16x32_bf16 v[152:155], v[224:227], a[188:191], v[152:155]
    ds_read_b128 a[168:171], v10 offset:4096
    ds_read_b128 a[172:175], v11 offset:4096
    v_mfma_f32_16x16x32_bf16 v[156:159], v[224:227], a[192:195], v[156:159]
    v_exp_f32 v218, v218
    v_mfma_f32_16x16x32_bf16 v[160:163], v[224:227], a[196:199], v[160:163]
    buffer_load_dwordx4 v23, s[16:19], s55 offen offset:3072 lds
    v_mfma_f32_16x16x32_bf16 v[164:167], v[224:227], a[200:203], v[164:167]
    s_add_u32 m0, s33, 0x6000
    v_exp_f32 v219, v219
    v_mfma_f32_16x16x32_bf16 v[240:243], v[224:227], a[204:207], v[240:243]
    v_cvt_pk_bf16_f32 v228, v216, v217
    v_cvt_pk_bf16_f32 v229, v218, v219
    v_mfma_f32_16x16x32_bf16 v[72:75], a[176:179], v[224:227], v[72:75]
    v_exp_f32 v220, v220
    v_mfma_f32_16x16x32_bf16 v[76:79], a[180:183], v[224:227], v[76:79]
    s_waitcnt lgkmcnt(0)
    buffer_load_dwordx4 v24, s[20:23], s54 offen lds
    v_mfma_f32_16x16x32_bf16 v[208:211], a[144:147], a[0:3], v[184:187]
    v_exp_f32 v221, v221
    v_mfma_f32_16x16x32_bf16 v[208:211], a[148:151], a[4:7], v[208:211]
    buffer_load_dwordx4 v25, s[20:23], s54 offen offset:1024 lds
    v_mfma_f32_16x16x32_bf16 v[208:211], a[152:155], a[8:11], v[208:211]
    v_exp_f32 v222, v222
    v_mfma_f32_16x16x32_bf16 v[208:211], a[156:159], a[12:15], v[208:211]
    buffer_load_dwordx4 v24, s[20:23], s54 offen offset:2048 lds
    v_mfma_f32_16x16x32_bf16 v[212:215], a[160:163], a[0:3], v[184:187]
    v_exp_f32 v223, v223
    v_mfma_f32_16x16x32_bf16 v[212:215], a[164:167], a[4:7], v[212:215]
    v_cvt_pk_bf16_f32 v230, v220, v221
    v_cvt_pk_bf16_f32 v231, v222, v223
    v_mfma_f32_16x16x32_bf16 v[212:215], a[168:171], a[8:11], v[212:215]
    s_waitcnt vmcnt(11)
    buffer_load_dwordx4 v25, s[20:23], s54 offen offset:3072 lds
    v_mfma_f32_16x16x32_bf16 v[212:215], a[172:175], a[12:15], v[212:215]
    s_add_u32 m0, s33, 0x7000
    v_exp_f32 v208, v208
    v_smfmac_f32_16x16x64_bf16 v[252:255], a[240:243], v[224:231], v6
    buffer_load_dwordx4 v24, s[20:23], s55 offen lds
    v_mfma_f32_16x16x32_bf16 v[232:235], v[228:231], a[184:187], v[232:235]
    v_exp_f32 v209, v209
    v_mfma_f32_16x16x32_bf16 v[168:171], v[228:231], a[188:191], v[168:171]
    ds_read_b64_tr_b16 a[184:185], v14 offset:8192
    ds_read_b64_tr_b16 a[186:187], v14 offset:12288
    v_mfma_f32_16x16x32_bf16 v[172:175], v[228:231], a[192:195], v[172:175]
    v_exp_f32 v210, v210
    v_mfma_f32_16x16x32_bf16 v[176:179], v[228:231], a[196:199], v[176:179]
    ds_read_b64_tr_b16 a[188:189], v15 offset:8192
    ds_read_b64_tr_b16 a[190:191], v15 offset:12288
    buffer_load_dwordx4 v25, s[20:23], s55 offen offset:1024 lds
    v_mfma_f32_16x16x32_bf16 v[180:183], v[228:231], a[200:203], v[180:183]
    v_exp_f32 v211, v211
    v_mfma_f32_16x16x32_bf16 v[248:251], v[228:231], a[204:207], v[248:251]
    v_cvt_pk_bf16_f32 v224, v208, v209
    v_cvt_pk_bf16_f32 v225, v210, v211
    v_mfma_f32_16x16x32_bf16 v[80:83], a[176:179], v[228:231], v[80:83]
    v_exp_f32 v212, v212
    v_mfma_f32_16x16x32_bf16 v[84:87], a[180:183], v[228:231], v[84:87]
    ds_read_b64_tr_b16 a[192:193], v16 offset:8192
    ds_read_b64_tr_b16 a[194:195], v16 offset:12288
    v_mfma_f32_16x16x32_bf16 v[216:219], a[144:147], a[16:19], v[188:191]
    v_exp_f32 v213, v213
    v_mfma_f32_16x16x32_bf16 v[216:219], a[148:151], a[20:23], v[216:219]
    ds_read_b64_tr_b16 a[196:197], v17 offset:8192
    ds_read_b64_tr_b16 a[198:199], v17 offset:12288
    v_mfma_f32_16x16x32_bf16 v[216:219], a[152:155], a[24:27], v[216:219]
    v_exp_f32 v214, v214
    v_mfma_f32_16x16x32_bf16 v[216:219], a[156:159], a[28:31], v[216:219]
    ds_read_b64_tr_b16 a[200:201], v18 offset:8192
    ds_read_b64_tr_b16 a[202:203], v18 offset:12288
    v_mfma_f32_16x16x32_bf16 v[220:223], a[160:163], a[16:19], v[188:191]
    v_exp_f32 v215, v215
    v_mfma_f32_16x16x32_bf16 v[220:223], a[164:167], a[20:23], v[220:223]
    v_cvt_pk_bf16_f32 v226, v212, v213
    v_cvt_pk_bf16_f32 v227, v214, v215
    v_mfma_f32_16x16x32_bf16 v[220:223], a[168:171], a[24:27], v[220:223]
    ds_read_b64_tr_b16 a[204:205], v19 offset:8192
    ds_read_b64_tr_b16 a[206:207], v19 offset:12288
    ds_read_b64_tr_b16 a[176:177], v12 offset:8192
    v_mfma_f32_16x16x32_bf16 v[220:223], a[172:175], a[28:31], v[220:223]
    ds_read_b64_tr_b16 a[178:179], v12 offset:12288
    v_exp_f32 v216, v216
    s_waitcnt lgkmcnt(6)
    v_mfma_f32_16x16x32_bf16 a[96:99], a[184:187], v[224:227], a[96:99]
    v_exp_f32 v217, v217
    v_mfma_f32_16x16x32_bf16 v[88:91], v[224:227], a[188:191], v[88:91]
    ds_read_b64_tr_b16 a[180:181], v13 offset:8192
    ds_read_b64_tr_b16 a[182:183], v13 offset:12288
    v_mfma_f32_16x16x32_bf16 v[92:95], v[224:227], a[192:195], v[92:95]
    v_exp_f32 v218, v218
    v_mfma_f32_16x16x32_bf16 v[96:99], v[224:227], a[196:199], v[96:99]
    s_waitcnt lgkmcnt(0)
    buffer_load_dwordx4 v24, s[20:23], s55 offen offset:2048 lds
    v_mfma_f32_16x16x32_bf16 v[100:103], v[224:227], a[200:203], v[100:103]
    v_exp_f32 v219, v219
    v_mfma_f32_16x16x32_bf16 a[100:103], a[204:207], v[224:227], a[100:103]
    v_cvt_pk_bf16_f32 v228, v216, v217
    v_cvt_pk_bf16_f32 v229, v218, v219
    v_mfma_f32_16x16x32_bf16 v[40:43], a[176:179], v[224:227], v[40:43]
    v_exp_f32 v220, v220
    v_mfma_f32_16x16x32_bf16 v[44:47], a[180:183], v[224:227], v[44:47]
    buffer_load_dwordx4 v25, s[20:23], s55 offen offset:3072 lds
    v_mfma_f32_16x16x32_bf16 v[208:211], a[144:147], a[32:35], v[192:195]
    s_mov_b32 m0, s33
    v_exp_f32 v221, v221
    v_mfma_f32_16x16x32_bf16 v[208:211], a[148:151], a[36:39], v[208:211]
    buffer_load_dwordx4 v20, s[16:19], s56 offen lds
    v_mfma_f32_16x16x32_bf16 v[208:211], a[152:155], a[40:43], v[208:211]
    v_exp_f32 v222, v222
    v_mfma_f32_16x16x32_bf16 v[208:211], a[156:159], a[44:47], v[208:211]
    buffer_load_dwordx4 v21, s[16:19], s56 offen offset:1024 lds
    v_mfma_f32_16x16x32_bf16 v[212:215], a[160:163], a[32:35], v[192:195]
    v_exp_f32 v223, v223
    v_mfma_f32_16x16x32_bf16 v[212:215], a[164:167], a[36:39], v[212:215]
    v_cvt_pk_bf16_f32 v230, v220, v221
    v_cvt_pk_bf16_f32 v231, v222, v223
    v_mfma_f32_16x16x32_bf16 v[212:215], a[168:171], a[40:43], v[212:215]
    buffer_load_dwordx4 v22, s[16:19], s56 offen offset:2048 lds
    v_mfma_f32_16x16x32_bf16 v[212:215], a[172:175], a[44:47], v[212:215]
    v_exp_f32 v208, v208
    v_smfmac_f32_16x16x64_bf16 v[236:239], a[240:243], v[224:231], v6
    v_mfma_f32_16x16x32_bf16 a[104:107], a[184:187], v[228:231], a[104:107]
    v_exp_f32 v209, v209
    v_mfma_f32_16x16x32_bf16 v[104:107], v[228:231], a[188:191], v[104:107]
    buffer_load_dwordx4 v23, s[16:19], s56 offen offset:3072 lds
    v_mfma_f32_16x16x32_bf16 v[108:111], v[228:231], a[192:195], v[108:111]
    s_add_u32 m0, s33, 0x1000
    v_exp_f32 v210, v210
    v_mfma_f32_16x16x32_bf16 v[112:115], v[228:231], a[196:199], v[112:115]
    buffer_load_dwordx4 v20, s[16:19], s57 offen lds
    v_mfma_f32_16x16x32_bf16 v[116:119], v[228:231], a[200:203], v[116:119]
    v_exp_f32 v211, v211
    v_mfma_f32_16x16x32_bf16 a[108:111], a[204:207], v[228:231], a[108:111]
    v_cvt_pk_bf16_f32 v224, v208, v209
    v_cvt_pk_bf16_f32 v225, v210, v211
    v_mfma_f32_16x16x32_bf16 v[48:51], a[176:179], v[228:231], v[48:51]
    v_exp_f32 v212, v212
    v_mfma_f32_16x16x32_bf16 v[52:55], a[180:183], v[228:231], v[52:55]
    buffer_load_dwordx4 v21, s[16:19], s57 offen offset:1024 lds
    v_mfma_f32_16x16x32_bf16 v[216:219], a[144:147], a[48:51], v[196:199]
    v_exp_f32 v213, v213
    v_mfma_f32_16x16x32_bf16 v[216:219], a[148:151], a[52:55], v[216:219]
    buffer_load_dwordx4 v22, s[16:19], s57 offen offset:2048 lds
    v_mfma_f32_16x16x32_bf16 v[216:219], a[152:155], a[56:59], v[216:219]
    v_exp_f32 v214, v214
    v_mfma_f32_16x16x32_bf16 v[216:219], a[156:159], a[60:63], v[216:219]
    v_mfma_f32_16x16x32_bf16 v[220:223], a[160:163], a[48:51], v[196:199]
    v_exp_f32 v215, v215
    v_mfma_f32_16x16x32_bf16 v[220:223], a[164:167], a[52:55], v[220:223]
    v_cvt_pk_bf16_f32 v226, v212, v213
    v_cvt_pk_bf16_f32 v227, v214, v215
    v_mfma_f32_16x16x32_bf16 v[220:223], a[168:171], a[56:59], v[220:223]
    buffer_load_dwordx4 v23, s[16:19], s57 offen offset:3072 lds
    v_mfma_f32_16x16x32_bf16 v[220:223], a[172:175], a[60:63], v[220:223]
    v_exp_f32 v216, v216
    v_mfma_f32_16x16x32_bf16 a[112:115], a[184:187], v[224:227], a[112:115]
    v_exp_f32 v217, v217
    v_mfma_f32_16x16x32_bf16 v[120:123], v[224:227], a[188:191], v[120:123]
    v_mfma_f32_16x16x32_bf16 v[124:127], v[224:227], a[192:195], v[124:127]
    v_exp_f32 v218, v218
    v_mfma_f32_16x16x32_bf16 v[128:131], v[224:227], a[196:199], v[128:131]
    v_mfma_f32_16x16x32_bf16 v[132:135], v[224:227], a[200:203], v[132:135]
    v_exp_f32 v219, v219
    v_mfma_f32_16x16x32_bf16 a[116:119], a[204:207], v[224:227], a[116:119]
    v_cvt_pk_bf16_f32 v228, v216, v217
    v_cvt_pk_bf16_f32 v229, v218, v219
    v_mfma_f32_16x16x32_bf16 v[56:59], a[176:179], v[224:227], v[56:59]
    v_exp_f32 v220, v220
    v_mfma_f32_16x16x32_bf16 v[60:63], a[180:183], v[224:227], v[60:63]
    v_mfma_f32_16x16x32_bf16 v[208:211], a[144:147], a[64:67], v[200:203]
    v_exp_f32 v221, v221
    v_mfma_f32_16x16x32_bf16 v[208:211], a[148:151], a[68:71], v[208:211]
    v_mfma_f32_16x16x32_bf16 v[208:211], a[152:155], a[72:75], v[208:211]
    v_exp_f32 v222, v222
    v_mfma_f32_16x16x32_bf16 v[208:211], a[156:159], a[76:79], v[208:211]
    v_mfma_f32_16x16x32_bf16 v[212:215], a[160:163], a[64:67], v[200:203]
    v_exp_f32 v223, v223
    v_mfma_f32_16x16x32_bf16 v[212:215], a[164:167], a[68:71], v[212:215]
    v_cvt_pk_bf16_f32 v230, v220, v221
    v_cvt_pk_bf16_f32 v231, v222, v223
    v_mfma_f32_16x16x32_bf16 v[212:215], a[168:171], a[72:75], v[212:215]
    v_mfma_f32_16x16x32_bf16 v[212:215], a[172:175], a[76:79], v[212:215]
    v_exp_f32 v208, v208
    v_smfmac_f32_16x16x64_bf16 v[244:247], a[240:243], v[224:231], v6
    v_mfma_f32_16x16x32_bf16 a[120:123], a[184:187], v[228:231], a[120:123]
    v_exp_f32 v209, v209
    v_mfma_f32_16x16x32_bf16 v[136:139], v[228:231], a[188:191], v[136:139]
    v_mfma_f32_16x16x32_bf16 v[140:143], v[228:231], a[192:195], v[140:143]
    v_exp_f32 v210, v210
    v_mfma_f32_16x16x32_bf16 v[144:147], v[228:231], a[196:199], v[144:147]
    v_mfma_f32_16x16x32_bf16 v[148:151], v[228:231], a[200:203], v[148:151]
    v_exp_f32 v211, v211
    v_mfma_f32_16x16x32_bf16 a[124:127], a[204:207], v[228:231], a[124:127]
    v_cvt_pk_bf16_f32 v224, v208, v209
    v_cvt_pk_bf16_f32 v225, v210, v211
    v_mfma_f32_16x16x32_bf16 v[64:67], a[176:179], v[228:231], v[64:67]
    s_waitcnt vmcnt(16)
    v_exp_f32 v212, v212
    v_mfma_f32_16x16x32_bf16 v[68:71], a[180:183], v[228:231], v[68:71]
    v_mfma_f32_16x16x32_bf16 v[216:219], a[144:147], a[80:83], v[204:207]
    v_exp_f32 v213, v213
    v_mfma_f32_16x16x32_bf16 v[216:219], a[148:151], a[84:87], v[216:219]
    ds_read_b128 a[144:147], v8 offset:16384
    ds_read_b128 a[148:151], v9 offset:16384
    v_mfma_f32_16x16x32_bf16 v[216:219], a[152:155], a[88:91], v[216:219]
    v_exp_f32 v214, v214
    v_mfma_f32_16x16x32_bf16 v[216:219], a[156:159], a[92:95], v[216:219]
    ds_read_b128 a[152:155], v10 offset:16384
    ds_read_b128 a[156:159], v11 offset:16384
    v_mfma_f32_16x16x32_bf16 v[220:223], a[160:163], a[80:83], v[204:207]
    v_exp_f32 v215, v215
    v_mfma_f32_16x16x32_bf16 v[220:223], a[164:167], a[84:87], v[220:223]
    v_cvt_pk_bf16_f32 v226, v212, v213
    v_cvt_pk_bf16_f32 v227, v214, v215
    v_mfma_f32_16x16x32_bf16 v[220:223], a[168:171], a[88:91], v[220:223]
    ds_read_b128 a[160:163], v8 offset:20480
    ds_read_b128 a[164:167], v9 offset:20480
    v_mfma_f32_16x16x32_bf16 v[220:223], a[172:175], a[92:95], v[220:223]
    v_exp_f32 v216, v216
    v_mfma_f32_16x16x32_bf16 a[128:131], a[184:187], v[224:227], a[128:131]
    s_add_u32 m0, s33, 0x2000
    v_exp_f32 v217, v217
    v_mfma_f32_16x16x32_bf16 v[152:155], v[224:227], a[188:191], v[152:155]
    ds_read_b128 a[168:171], v10 offset:20480
    ds_read_b128 a[172:175], v11 offset:20480
    v_mfma_f32_16x16x32_bf16 v[156:159], v[224:227], a[192:195], v[156:159]
    v_exp_f32 v218, v218
    v_mfma_f32_16x16x32_bf16 v[160:163], v[224:227], a[196:199], v[160:163]
    buffer_load_dwordx4 v24, s[20:23], s56 offen lds
    v_mfma_f32_16x16x32_bf16 v[164:167], v[224:227], a[200:203], v[164:167]
    v_exp_f32 v219, v219
    v_mfma_f32_16x16x32_bf16 v[240:243], v[224:227], a[204:207], v[240:243]
    v_cvt_pk_bf16_f32 v228, v216, v217
    v_cvt_pk_bf16_f32 v229, v218, v219
    v_mfma_f32_16x16x32_bf16 v[72:75], a[176:179], v[224:227], v[72:75]
    v_exp_f32 v220, v220
    v_mfma_f32_16x16x32_bf16 v[76:79], a[180:183], v[224:227], v[76:79]
    s_waitcnt lgkmcnt(0)
    buffer_load_dwordx4 v25, s[20:23], s56 offen offset:1024 lds
    v_mfma_f32_16x16x32_bf16 v[208:211], a[144:147], a[0:3], v[184:187]
    v_exp_f32 v221, v221
    v_mfma_f32_16x16x32_bf16 v[208:211], a[148:151], a[4:7], v[208:211]
    buffer_load_dwordx4 v24, s[20:23], s56 offen offset:2048 lds
    v_mfma_f32_16x16x32_bf16 v[208:211], a[152:155], a[8:11], v[208:211]
    s_bfe_u32 s58, s41, 0x4001c
    v_exp_f32 v222, v222
    v_mfma_f32_16x16x32_bf16 v[208:211], a[156:159], a[12:15], v[208:211]
    buffer_load_dwordx4 v25, s[20:23], s56 offen offset:3072 lds
    v_mfma_f32_16x16x32_bf16 v[212:215], a[160:163], a[0:3], v[184:187]
    s_mul_i32 s58, s58, 0x2000
    v_exp_f32 v223, v223
    v_mfma_f32_16x16x32_bf16 v[212:215], a[164:167], a[4:7], v[212:215]
    s_add_u32 s58, s58, s44
    v_cvt_pk_bf16_f32 v230, v220, v221
    v_cvt_pk_bf16_f32 v231, v222, v223
    v_mfma_f32_16x16x32_bf16 v[212:215], a[168:171], a[8:11], v[212:215]
    s_waitcnt vmcnt(12)
    v_mfma_f32_16x16x32_bf16 v[212:215], a[172:175], a[12:15], v[212:215]
    s_add_u32 m0, s33, 0x3000
    v_exp_f32 v208, v208
    v_smfmac_f32_16x16x64_bf16 v[252:255], a[240:243], v[224:231], v6
    buffer_load_dwordx4 v24, s[20:23], s57 offen lds
    v_mfma_f32_16x16x32_bf16 v[232:235], v[228:231], a[184:187], v[232:235]
    s_and_b32 s58, s58, 0x1ffff
    v_exp_f32 v209, v209
    v_mfma_f32_16x16x32_bf16 v[168:171], v[228:231], a[188:191], v[168:171]
    s_add_u32 s59, s58, 0x1000
    ds_read_b64_tr_b16 a[184:185], v14 offset:24576
    ds_read_b64_tr_b16 a[186:187], v14 offset:28672
    v_mfma_f32_16x16x32_bf16 v[172:175], v[228:231], a[192:195], v[172:175]
    v_exp_f32 v210, v210
    v_mfma_f32_16x16x32_bf16 v[176:179], v[228:231], a[196:199], v[176:179]
    ds_read_b64_tr_b16 a[188:189], v15 offset:24576
    ds_read_b64_tr_b16 a[190:191], v15 offset:28672
    buffer_load_dwordx4 v25, s[20:23], s57 offen offset:1024 lds
    v_mfma_f32_16x16x32_bf16 v[180:183], v[228:231], a[200:203], v[180:183]
    v_exp_f32 v211, v211
    v_mfma_f32_16x16x32_bf16 v[248:251], v[228:231], a[204:207], v[248:251]
    v_cvt_pk_bf16_f32 v224, v208, v209
    v_cvt_pk_bf16_f32 v225, v210, v211
    v_mfma_f32_16x16x32_bf16 v[80:83], a[176:179], v[228:231], v[80:83]
    v_exp_f32 v212, v212
    v_mfma_f32_16x16x32_bf16 v[84:87], a[180:183], v[228:231], v[84:87]
    ds_read_b64_tr_b16 a[192:193], v16 offset:24576
    ds_read_b64_tr_b16 a[194:195], v16 offset:28672
    v_mfma_f32_16x16x32_bf16 v[216:219], a[144:147], a[16:19], v[188:191]
    v_exp_f32 v213, v213
    v_mfma_f32_16x16x32_bf16 v[216:219], a[148:151], a[20:23], v[216:219]
    ds_read_b64_tr_b16 a[196:197], v17 offset:24576
    ds_read_b64_tr_b16 a[198:199], v17 offset:28672
    v_mfma_f32_16x16x32_bf16 v[216:219], a[152:155], a[24:27], v[216:219]
    v_exp_f32 v214, v214
    v_mfma_f32_16x16x32_bf16 v[216:219], a[156:159], a[28:31], v[216:219]
    ds_read_b64_tr_b16 a[200:201], v18 offset:24576
    ds_read_b64_tr_b16 a[202:203], v18 offset:28672
    v_mfma_f32_16x16x32_bf16 v[220:223], a[160:163], a[16:19], v[188:191]
    v_exp_f32 v215, v215
    v_mfma_f32_16x16x32_bf16 v[220:223], a[164:167], a[20:23], v[220:223]
L_t3:
    s_cbranch_vccnz L_tr
    v_cvt_pk_bf16_f32 v226, v212, v213
    v_cvt_pk_bf16_f32 v227, v214, v215
    v_mfma_f32_16x16x32_bf16 v[220:223], a[168:171], a[24:27], v[220:223]
    ds_read_b64_tr_b16 a[204:205], v19 offset:24576
    ds_read_b64_tr_b16 a[206:207], v19 offset:28672
    ds_read_b64_tr_b16 a[176:177], v12 offset:24576
    v_mfma_f32_16x16x32_bf16 v[220:223], a[172:175], a[28:31], v[220:223]
    ds_read_b64_tr_b16 a[178:179], v12 offset:28672
    v_exp_f32 v216, v216
    s_waitcnt lgkmcnt(6)
    v_mfma_f32_16x16x32_bf16 a[96:99], a[184:187], v[224:227], a[96:99]
    v_exp_f32 v217, v217
    v_mfma_f32_16x16x32_bf16 v[88:91], v[224:227], a[188:191], v[88:91]
    ds_read_b64_tr_b16 a[180:181], v13 offset:24576
    ds_read_b64_tr_b16 a[182:183], v13 offset:28672
    v_mfma_f32_16x16x32_bf16 v[92:95], v[224:227], a[192:195], v[92:95]
    v_exp_f32 v218, v218
    v_mfma_f32_16x16x32_bf16 v[96:99], v[224:227], a[196:199], v[96:99]
    s_waitcnt lgkmcnt(0)
    buffer_load_dwordx4 v24, s[20:23], s57 offen offset:2048 lds
    v_mfma_f32_16x16x32_bf16 v[100:103], v[224:227], a[200:203], v[100:103]
    v_exp_f32 v219, v219
    v_mfma_f32_16x16x32_bf16 a[100:103], a[204:207], v[224:227], a[100:103]
    v_cvt_pk_bf16_f32 v228, v216, v217
    v_cvt_pk_bf16_f32 v229, v218, v219
    v_mfma_f32_16x16x32_bf16 v[40:43], a[176:179], v[224:227], v[40:43]
    v_exp_f32 v220, v220
    v_mfma_f32_16x16x32_bf16 v[44:47], a[180:183], v[224:227], v[44:47]
    buffer_load_dwordx4 v25, s[20:23], s57 offen offset:3072 lds
    v_mfma_f32_16x16x32_bf16 v[208:211], a[144:147], a[32:35], v[192:195]
    v_exp_f32 v221, v221
    v_mfma_f32_16x16x32_bf16 v[208:211], a[148:151], a[36:39], v[208:211]
    v_mfma_f32_16x16x32_bf16 v[208:211], a[152:155], a[40:43], v[208:211]
    v_exp_f32 v222, v222
    v_mfma_f32_16x16x32_bf16 v[208:211], a[156:159], a[44:47], v[208:211]
    v_mfma_f32_16x16x32_bf16 v[212:215], a[160:163], a[32:35], v[192:195]
    v_exp_f32 v223, v223
    v_mfma_f32_16x16x32_bf16 v[212:215], a[164:167], a[36:39], v[212:215]
    v_cvt_pk_bf16_f32 v230, v220, v221
    v_cvt_pk_bf16_f32 v231, v222, v223
    v_mfma_f32_16x16x32_bf16 v[212:215], a[168:171], a[40:43], v[212:215]
    v_mfma_f32_16x16x32_bf16 v[212:215], a[172:175], a[44:47], v[212:215]
    v_exp_f32 v208, v208
    v_smfmac_f32_16x16x64_bf16 v[236:239], a[240:243], v[224:231], v6
    v_mfma_f32_16x16x32_bf16 a[104:107], a[184:187], v[228:231], a[104:107]
    v_exp_f32 v209, v209
    v_mfma_f32_16x16x32_bf16 v[104:107], v[228:231], a[188:191], v[104:107]
    v_mfma_f32_16x16x32_bf16 v[108:111], v[228:231], a[192:195], v[108:111]
    v_exp_f32 v210, v210
    v_mfma_f32_16x16x32_bf16 v[112:115], v[228:231], a[196:199], v[112:115]
    v_mfma_f32_16x16x32_bf16 v[116:119], v[228:231], a[200:203], v[116:119]
    v_exp_f32 v211, v211
    v_mfma_f32_16x16x32_bf16 a[108:111], a[204:207], v[228:231], a[108:111]
    v_cvt_pk_bf16_f32 v224, v208, v209
    v_cvt_pk_bf16_f32 v225, v210, v211
    v_mfma_f32_16x16x32_bf16 v[48:51], a[176:179], v[228:231], v[48:51]
    v_exp_f32 v212, v212
    v_mfma_f32_16x16x32_bf16 v[52:55], a[180:183], v[228:231], v[52:55]
    v_mfma_f32_16x16x32_bf16 v[216:219], a[144:147], a[48:51], v[196:199]
    v_exp_f32 v213, v213
    v_mfma_f32_16x16x32_bf16 v[216:219], a[148:151], a[52:55], v[216:219]
    v_mfma_f32_16x16x32_bf16 v[216:219], a[152:155], a[56:59], v[216:219]
    v_exp_f32 v214, v214
    v_mfma_f32_16x16x32_bf16 v[216:219], a[156:159], a[60:63], v[216:219]
    v_mfma_f32_16x16x32_bf16 v[220:223], a[160:163], a[48:51], v[196:199]
    v_exp_f32 v215, v215
    v_mfma_f32_16x16x32_bf16 v[220:223], a[164:167], a[52:55], v[220:223]
    v_cvt_pk_bf16_f32 v226, v212, v213
    v_cvt_pk_bf16_f32 v227, v214, v215
    v_mfma_f32_16x16x32_bf16 v[220:223], a[168:171], a[56:59], v[220:223]
    v_mfma_f32_16x16x32_bf16 v[220:223], a[172:175], a[60:63], v[220:223]
    v_exp_f32 v216, v216
    v_mfma_f32_16x16x32_bf16 a[112:115], a[184:187], v[224:227], a[112:115]
    s_add_u32 m0, s33, 0x4000
    v_exp_f32 v217, v217
    v_mfma_f32_16x16x32_bf16 v[120:123], v[224:227], a[188:191], v[120:123]
    buffer_load_dwordx4 v20, s[16:19], s58 offen lds
    v_mfma_f32_16x16x32_bf16 v[124:127], v[224:227], a[192:195], v[124:127]
    v_exp_f32 v218, v218
    v_mfma_f32_16x16x32_bf16 v[128:131], v[224:227], a[196:199], v[128:131]
    buffer_load_dwordx4 v21, s[16:19], s58 offen offset:1024 lds
    v_mfma_f32_16x16x32_bf16 v[132:135], v[224:227], a[200:203], v[132:135]
    v_exp_f32 v219, v219
    v_mfma_f32_16x16x32_bf16 a[116:119], a[204:207], v[224:227], a[116:119]
    v_cvt_pk_bf16_f32 v228, v216, v217
    v_cvt_pk_bf16_f32 v229, v218, v219
    v_mfma_f32_16x16x32_bf16 v[56:59], a[176:179], v[224:227], v[56:59]
    v_exp_f32 v220, v220
    v_mfma_f32_16x16x32_bf16 v[60:63], a[180:183], v[224:227], v[60:63]
    buffer_load_dwordx4 v22, s[16:19], s58 offen offset:2048 lds
    v_mfma_f32_16x16x32_bf16 v[208:211], a[144:147], a[64:67], v[200:203]
    v_exp_f32 v221, v221
    v_mfma_f32_16x16x32_bf16 v[208:211], a[148:151], a[68:71], v[208:211]
    v_mfma_f32_16x16x32_bf16 v[208:211], a[152:155], a[72:75], v[208:211]
    v_exp_f32 v222, v222
    v_mfma_f32_16x16x32_bf16 v[208:211], a[156:159], a[76:79], v[208:211]
    buffer_load_dwordx4 v23, s[16:19], s58 offen offset:3072 lds
    v_mfma_f32_16x16x32_bf16 v[212:215], a[160:163], a[64:67], v[200:203]
    v_exp_f32 v223, v223
    v_mfma_f32_16x16x32_bf16 v[212:215], a[164:167], a[68:71], v[212:215]
    v_cvt_pk_bf16_f32 v230, v220, v221
    v_cvt_pk_bf16_f32 v231, v222, v223
    v_mfma_f32_16x16x32_bf16 v[212:215], a[168:171], a[72:75], v[212:215]
    v_mfma_f32_16x16x32_bf16 v[212:215], a[172:175], a[76:79], v[212:215]
    s_add_u32 m0, s33, 0x5000
    v_exp_f32 v208, v208
    v_smfmac_f32_16x16x64_bf16 v[244:247], a[240:243], v[224:231], v6
    v_mfma_f32_16x16x32_bf16 a[120:123], a[184:187], v[228:231], a[120:123]
    s_bfe_u32 s60, s42, 0x40000
    v_exp_f32 v209, v209
    v_mfma_f32_16x16x32_bf16 v[136:139], v[228:231], a[188:191], v[136:139]
    buffer_load_dwordx4 v20, s[16:19], s59 offen lds
    v_mfma_f32_16x16x32_bf16 v[140:143], v[228:231], a[192:195], v[140:143]
    s_mul_i32 s60, s60, 0x2000
    v_exp_f32 v210, v210
    v_mfma_f32_16x16x32_bf16 v[144:147], v[228:231], a[196:199], v[144:147]
    buffer_load_dwordx4 v21, s[16:19], s59 offen offset:1024 lds
    v_mfma_f32_16x16x32_bf16 v[148:151], v[228:231], a[200:203], v[148:151]
    s_add_u32 s60, s60, s44
    v_exp_f32 v211, v211
    v_mfma_f32_16x16x32_bf16 a[124:127], a[204:207], v[228:231], a[124:127]
    s_and_b32 s60, s60, 0x1ffff
    v_cvt_pk_bf16_f32 v224, v208, v209
    v_cvt_pk_bf16_f32 v225, v210, v211
    v_mfma_f32_16x16x32_bf16 v[64:67], a[176:179], v[228:231], v[64:67]
    s_waitcnt vmcnt(14)
    v_exp_f32 v212, v212
    v_mfma_f32_16x16x32_bf16 v[68:71], a[180:183], v[228:231], v[68:71]
    buffer_load_dwordx4 v22, s[16:19], s59 offen offset:2048 lds
    v_mfma_f32_16x16x32_bf16 v[216:219], a[144:147], a[80:83], v[204:207]
    s_add_u32 s61, s60, 0x1000
    v_exp_f32 v213, v213
    v_mfma_f32_16x16x32_bf16 v[216:219], a[148:151], a[84:87], v[216:219]
    ds_read_b128 a[144:147], v8
    ds_read_b128 a[148:151], v9
    v_mfma_f32_16x16x32_bf16 v[216:219], a[152:155], a[88:91], v[216:219]
    v_exp_f32 v214, v214
    v_mfma_f32_16x16x32_bf16 v[216:219], a[156:159], a[92:95], v[216:219]
    ds_read_b128 a[152:155], v10
    ds_read_b128 a[156:159], v11
    v_mfma_f32_16x16x32_bf16 v[220:223], a[160:163], a[80:83], v[204:207]
    v_exp_f32 v215, v215
    v_mfma_f32_16x16x32_bf16 v[220:223], a[164:167], a[84:87], v[220:223]
    v_cvt_pk_bf16_f32 v226, v212, v213
    v_cvt_pk_bf16_f32 v227, v214, v215
    v_mfma_f32_16x16x32_bf16 v[220:223], a[168:171], a[88:91], v[220:223]
    ds_read_b128 a[160:163], v8 offset:4096
    ds_read_b128 a[164:167], v9 offset:4096
    v_mfma_f32_16x16x32_bf16 v[220:223], a[172:175], a[92:95], v[220:223]
    v_exp_f32 v216, v216
    v_mfma_f32_16x16x32_bf16 a[128:131], a[184:187], v[224:227], a[128:131]
    v_exp_f32 v217, v217
    v_mfma_f32_16x16x32_bf16 v[152:155], v[224:227], a[188:191], v[152:155]
    ds_read_b128 a[168:171], v10 offset:4096
    ds_read_b128 a[172:175], v11 offset:4096
    v_mfma_f32_16x16x32_bf16 v[156:159], v[224:227], a[192:195], v[156:159]
    v_exp_f32 v218, v218
    v_mfma_f32_16x16x32_bf16 v[160:163], v[224:227], a[196:199], v[160:163]
    buffer_load_dwordx4 v23, s[16:19], s59 offen offset:3072 lds
    v_mfma_f32_16x16x32_bf16 v[164:167], v[224:227], a[200:203], v[164:167]
    s_add_u32 m0, s33, 0x6000
    v_exp_f32 v219, v219
    v_mfma_f32_16x16x32_bf16 v[240:243], v[224:227], a[204:207], v[240:243]
    v_cvt_pk_bf16_f32 v228, v216, v217
    v_cvt_pk_bf16_f32 v229, v218, v219
    v_mfma_f32_16x16x32_bf16 v[72:75], a[176:179], v[224:227], v[72:75]
    v_exp_f32 v220, v220
    v_mfma_f32_16x16x32_bf16 v[76:79], a[180:183], v[224:227], v[76:79]
    s_waitcnt lgkmcnt(0)
    buffer_load_dwordx4 v24, s[20:23], s58 offen lds
    v_mfma_f32_16x16x32_bf16 v[208:211], a[144:147], a[0:3], v[184:187]
    v_exp_f32 v221, v221
    v_mfma_f32_16x16x32_bf16 v[208:211], a[148:151], a[4:7], v[208:211]
    buffer_load_dwordx4 v25, s[20:23], s58 offen offset:1024 lds
    v_mfma_f32_16x16x32_bf16 v[208:211], a[152:155], a[8:11], v[208:211]
    v_exp_f32 v222, v222
    v_mfma_f32_16x16x32_bf16 v[208:211], a[156:159], a[12:15], v[208:211]
    buffer_load_dwordx4 v24, s[20:23], s58 offen offset:2048 lds
    v_mfma_f32_16x16x32_bf16 v[212:215], a[160:163], a[0:3], v[184:187]
    v_exp_f32 v223, v223
    v_mfma_f32_16x16x32_bf16 v[212:215], a[164:167], a[4:7], v[212:215]
    v_cvt_pk_bf16_f32 v230, v220, v221
    v_cvt_pk_bf16_f32 v231, v222, v223
    v_mfma_f32_16x16x32_bf16 v[212:215], a[168:171], a[8:11], v[212:215]
    s_waitcnt vmcnt(11)
    buffer_load_dwordx4 v25, s[20:23], s58 offen offset:3072 lds
    v_mfma_f32_16x16x32_bf16 v[212:215], a[172:175], a[12:15], v[212:215]
    s_add_u32 m0, s33, 0x7000
    v_exp_f32 v208, v208
    v_smfmac_f32_16x16x64_bf16 v[252:255], a[240:243], v[224:231], v6
    buffer_load_dwordx4 v24, s[20:23], s59 offen lds
    v_mfma_f32_16x16x32_bf16 v[232:235], v[228:231], a[184:187], v[232:235]
    v_exp_f32 v209, v209
    v_mfma_f32_16x16x32_bf16 v[168:171], v[228:231], a[188:191], v[168:171]
    ds_read_b64_tr_b16 a[184:185], v14 offset:8192
    ds_read_b64_tr_b16 a[186:187], v14 offset:12288
    v_mfma_f32_16x16x32_bf16 v[172:175], v[228:231], a[192:195], v[172:175]
    v_exp_f32 v210, v210
    v_mfma_f32_16x16x32_bf16 v[176:179], v[228:231], a[196:199], v[176:179]
    ds_read_b64_tr_b16 a[188:189], v15 offset:8192
    ds_read_b64_tr_b16 a[190:191], v15 offset:12288
    buffer_load_dwordx4 v25, s[20:23], s59 offen offset:1024 lds
    v_mfma_f32_16x16x32_bf16 v[180:183], v[228:231], a[200:203], v[180:183]
    v_exp_f32 v211, v211
    v_mfma_f32_16x16x32_bf16 v[248:251], v[228:231], a[204:207], v[248:251]
    v_cvt_pk_bf16_f32 v224, v208, v209
    v_cvt_pk_bf16_f32 v225, v210, v211
    v_mfma_f32_16x16x32_bf16 v[80:83], a[176:179], v[228:231], v[80:83]
    v_exp_f32 v212, v212
    v_mfma_f32_16x16x32_bf16 v[84:87], a[180:183], v[228:231], v[84:87]
    ds_read_b64_tr_b16 a[192:193], v16 offset:8192
    ds_read_b64_tr_b16 a[194:195], v16 offset:12288
    v_mfma_f32_16x16x32_bf16 v[216:219], a[144:147], a[16:19], v[188:191]
    v_exp_f32 v213, v213
    v_mfma_f32_16x16x32_bf16 v[216:219], a[148:151], a[20:23], v[216:219]
    ds_read_b64_tr_b16 a[196:197], v17 offset:8192
    ds_read_b64_tr_b16 a[198:199], v17 offset:12288
    v_mfma_f32_16x16x32_bf16 v[216:219], a[152:155], a[24:27], v[216:219]
    v_exp_f32 v214, v214
    v_mfma_f32_16x16x32_bf16 v[216:219], a[156:159], a[28:31], v[216:219]
    ds_read_b64_tr_b16 a[200:201], v18 offset:8192
    ds_read_b64_tr_b16 a[202:203], v18 offset:12288
    v_mfma_f32_16x16x32_bf16 v[220:223], a[160:163], a[16:19], v[188:191]
    v_exp_f32 v215, v215
    v_mfma_f32_16x16x32_bf16 v[220:223], a[164:167], a[20:23], v[220:223]
    v_cvt_pk_bf16_f32 v226, v212, v213
    v_cvt_pk_bf16_f32 v227, v214, v215
    v_mfma_f32_16x16x32_bf16 v[220:223], a[168:171], a[24:27], v[220:223]
    ds_read_b64_tr_b16 a[204:205], v19 offset:8192
    ds_read_b64_tr_b16 a[206:207], v19 offset:12288
    ds_read_b64_tr_b16 a[176:177], v12 offset:8192
    v_mfma_f32_16x16x32_bf16 v[220:223], a[172:175], a[28:31], v[220:223]
    ds_read_b64_tr_b16 a[178:179], v12 offset:12288
    v_exp_f32 v216, v216
    s_waitcnt lgkmcnt(6)
    v_mfma_f32_16x16x32_bf16 a[96:99], a[184:187], v[224:227], a[96:99]
    v_exp_f32 v217, v217
    v_mfma_f32_16x16x32_bf16 v[88:91], v[224:227], a[188:191], v[88:91]
    ds_read_b64_tr_b16 a[180:181], v13 offset:8192
    ds_read_b64_tr_b16 a[182:183], v13 offset:12288
    v_mfma_f32_16x16x32_bf16 v[92:95], v[224:227], a[192:195], v[92:95]
    v_exp_f32 v218, v218
    v_mfma_f32_16x16x32_bf16 v[96:99], v[224:227], a[196:199], v[96:99]
    s_waitcnt lgkmcnt(0)
    buffer_load_dwordx4 v24, s[20:23], s59 offen offset:2048 lds
    v_mfma_f32_16x16x32_bf16 v[100:103], v[224:227], a[200:203], v[100:103]
    v_exp_f32 v219, v219
    v_mfma_f32_16x16x32_bf16 a[100:103], a[204:207], v[224:227], a[100:103]
    v_cvt_pk_bf16_f32 v228, v216, v217
    v_cvt_pk_bf16_f32 v229, v218, v219
    v_mfma_f32_16x16x32_bf16 v[40:43], a[176:179], v[224:227], v[40:43]
    v_exp_f32 v220, v220
    v_mfma_f32_16x16x32_bf16 v[44:47], a[180:183], v[224:227], v[44:47]
    buffer_load_dwordx4 v25, s[20:23], s59 offen offset:3072 lds
    v_mfma_f32_16x16x32_bf16 v[208:211], a[144:147], a[32:35], v[192:195]
    s_mov_b32 m0, s33
    v_exp_f32 v221, v221
    v_mfma_f32_16x16x32_bf16 v[208:211], a[148:151], a[36:39], v[208:211]
    buffer_load_dwordx4 v20, s[16:19], s60 offen lds
    v_mfma_f32_16x16x32_bf16 v[208:211], a[152:155], a[40:43], v[208:211]
    v_exp_f32 v222, v222
    v_mfma_f32_16x16x32_bf16 v[208:211], a[156:159], a[44:47], v[208:211]
    buffer_load_dwordx4 v21, s[16:19], s60 offen offset:1024 lds
    v_mfma_f32_16x16x32_bf16 v[212:215], a[160:163], a[32:35], v[192:195]
    v_exp_f32 v223, v223
    v_mfma_f32_16x16x32_bf16 v[212:215], a[164:167], a[36:39], v[212:215]
    v_cvt_pk_bf16_f32 v230, v220, v221
    v_cvt_pk_bf16_f32 v231, v222, v223
    v_mfma_f32_16x16x32_bf16 v[212:215], a[168:171], a[40:43], v[212:215]
    buffer_load_dwordx4 v22, s[16:19], s60 offen offset:2048 lds
    v_mfma_f32_16x16x32_bf16 v[212:215], a[172:175], a[44:47], v[212:215]
    v_exp_f32 v208, v208
    v_smfmac_f32_16x16x64_bf16 v[236:239], a[240:243], v[224:231], v6
    v_mfma_f32_16x16x32_bf16 a[104:107], a[184:187], v[228:231], a[104:107]
    v_exp_f32 v209, v209
    v_mfma_f32_16x16x32_bf16 v[104:107], v[228:231], a[188:191], v[104:107]
    buffer_load_dwordx4 v23, s[16:19], s60 offen offset:3072 lds
    v_mfma_f32_16x16x32_bf16 v[108:111], v[228:231], a[192:195], v[108:111]
    s_add_u32 m0, s33, 0x1000
    v_exp_f32 v210, v210
    v_mfma_f32_16x16x32_bf16 v[112:115], v[228:231], a[196:199], v[112:115]
    buffer_load_dwordx4 v20, s[16:19], s61 offen lds
    v_mfma_f32_16x16x32_bf16 v[116:119], v[228:231], a[200:203], v[116:119]
    v_exp_f32 v211, v211
    v_mfma_f32_16x16x32_bf16 a[108:111], a[204:207], v[228:231], a[108:111]
    v_cvt_pk_bf16_f32 v224, v208, v209
    v_cvt_pk_bf16_f32 v225, v210, v211
    v_mfma_f32_16x16x32_bf16 v[48:51], a[176:179], v[228:231], v[48:51]
    v_exp_f32 v212, v212
    v_mfma_f32_16x16x32_bf16 v[52:55], a[180:183], v[228:231], v[52:55]
    buffer_load_dwordx4 v21, s[16:19], s61 offen offset:1024 lds
    v_mfma_f32_16x16x32_bf16 v[216:219], a[144:147], a[48:51], v[196:199]
    v_exp_f32 v213, v213
    v_mfma_f32_16x16x32_bf16 v[216:219], a[148:151], a[52:55], v[216:219]
    buffer_load_dwordx4 v22, s[16:19], s61 offen offset:2048 lds
    v_mfma_f32_16x16x32_bf16 v[216:219], a[152:155], a[56:59], v[216:219]
    v_exp_f32 v214, v214
    v_mfma_f32_16x16x32_bf16 v[216:219], a[156:159], a[60:63], v[216:219]
    v_mfma_f32_16x16x32_bf16 v[220:223], a[160:163], a[48:51], v[196:199]
    v_exp_f32 v215, v215
    v_mfma_f32_16x16x32_bf16 v[220:223], a[164:167], a[52:55], v[220:223]
    v_cvt_pk_bf16_f32 v226, v212, v213
    v_cvt_pk_bf16_f32 v227, v214, v215
    v_mfma_f32_16x16x32_bf16 v[220:223], a[168:171], a[56:59], v[220:223]
    buffer_load_dwordx4 v23, s[16:19], s61 offen offset:3072 lds
    v_mfma_f32_16x16x32_bf16 v[220:223], a[172:175], a[60:63], v[220:223]
    v_exp_f32 v216, v216
    v_mfma_f32_16x16x32_bf16 a[112:115], a[184:187], v[224:227], a[112:115]
    v_exp_f32 v217, v217
    v_mfma_f32_16x16x32_bf16 v[120:123], v[224:227], a[188:191], v[120:123]
    v_mfma_f32_16x16x32_bf16 v[124:127], v[224:227], a[192:195], v[124:127]
    v_exp_f32 v218, v218
    v_mfma_f32_16x16x32_bf16 v[128:131], v[224:227], a[196:199], v[128:131]
    v_mfma_f32_16x16x32_bf16 v[132:135], v[224:227], a[200:203], v[132:135]
    v_exp_f32 v219, v219
    v_mfma_f32_16x16x32_bf16 a[116:119], a[204:207], v[224:227], a[116:119]
    v_cvt_pk_bf16_f32 v228, v216, v217
    v_cvt_pk_bf16_f32 v229, v218, v219
    v_mfma_f32_16x16x32_bf16 v[56:59], a[176:179], v[224:227], v[56:59]
    v_exp_f32 v220, v220
    v_mfma_f32_16x16x32_bf16 v[60:63], a[180:183], v[224:227], v[60:63]
    v_mfma_f32_16x16x32_bf16 v[208:211], a[144:147], a[64:67], v[200:203]
    v_exp_f32 v221, v221
    v_mfma_f32_16x16x32_bf16 v[208:211], a[148:151], a[68:71], v[208:211]
    v_mfma_f32_16x16x32_bf16 v[208:211], a[152:155], a[72:75], v[208:211]
    v_exp_f32 v222, v222
    v_mfma_f32_16x16x32_bf16 v[208:211], a[156:159], a[76:79], v[208:211]
    v_mfma_f32_16x16x32_bf16 v[212:215], a[160:163], a[64:67], v[200:203]
    v_exp_f32 v223, v223
    v_mfma_f32_16x16x32_bf16 v[212:215], a[164:167], a[68:71], v[212:215]
    v_cvt_pk_bf16_f32 v230, v220, v221
    v_cvt_pk_bf16_f32 v231, v222, v223
    v_mfma_f32_16x16x32_bf16 v[212:215], a[168:171], a[72:75], v[212:215]
    v_mfma_f32_16x16x32_bf16 v[212:215], a[172:175], a[76:79], v[212:215]
    v_exp_f32 v208, v208
    v_smfmac_f32_16x16x64_bf16 v[244:247], a[240:243], v[224:231], v6
    v_mfma_f32_16x16x32_bf16 a[120:123], a[184:187], v[228:231], a[120:123]
    v_exp_f32 v209, v209
    v_mfma_f32_16x16x32_bf16 v[136:139], v[228:231], a[188:191], v[136:139]
    v_mfma_f32_16x16x32_bf16 v[140:143], v[228:231], a[192:195], v[140:143]
    v_exp_f32 v210, v210
    v_mfma_f32_16x16x32_bf16 v[144:147], v[228:231], a[196:199], v[144:147]
    v_mfma_f32_16x16x32_bf16 v[148:151], v[228:231], a[200:203], v[148:151]
    v_exp_f32 v211, v211
    v_mfma_f32_16x16x32_bf16 a[124:127], a[204:207], v[228:231], a[124:127]
    v_cvt_pk_bf16_f32 v224, v208, v209
    v_cvt_pk_bf16_f32 v225, v210, v211
    v_mfma_f32_16x16x32_bf16 v[64:67], a[176:179], v[228:231], v[64:67]
    s_waitcnt vmcnt(16)
    v_exp_f32 v212, v212
    v_mfma_f32_16x16x32_bf16 v[68:71], a[180:183], v[228:231], v[68:71]
    v_mfma_f32_16x16x32_bf16 v[216:219], a[144:147], a[80:83], v[204:207]
    v_exp_f32 v213, v213
    v_mfma_f32_16x16x32_bf16 v[216:219], a[148:151], a[84:87], v[216:219]
    ds_read_b128 a[144:147], v8 offset:16384
    ds_read_b128 a[148:151], v9 offset:16384
    v_mfma_f32_16x16x32_bf16 v[216:219], a[152:155], a[88:91], v[216:219]
    v_exp_f32 v214, v214
    v_mfma_f32_16x16x32_bf16 v[216:219], a[156:159], a[92:95], v[216:219]
    ds_read_b128 a[152:155], v10 offset:16384
    ds_read_b128 a[156:159], v11 offset:16384
    v_mfma_f32_16x16x32_bf16 v[220:223], a[160:163], a[80:83], v[204:207]
    v_exp_f32 v215, v215
    v_mfma_f32_16x16x32_bf16 v[220:223], a[164:167], a[84:87], v[220:223]
    v_cvt_pk_bf16_f32 v226, v212, v213
    v_cvt_pk_bf16_f32 v227, v214, v215
    v_mfma_f32_16x16x32_bf16 v[220:223], a[168:171], a[88:91], v[220:223]
    ds_read_b128 a[160:163], v8 offset:20480
    ds_read_b128 a[164:167], v9 offset:20480
    v_mfma_f32_16x16x32_bf16 v[220:223], a[172:175], a[92:95], v[220:223]
    v_exp_f32 v216, v216
    v_mfma_f32_16x16x32_bf16 a[128:131], a[184:187], v[224:227], a[128:131]
    s_add_u32 m0, s33, 0x2000
    v_exp_f32 v217, v217
    v_mfma_f32_16x16x32_bf16 v[152:155], v[224:227], a[188:191], v[152:155]
    ds_read_b128 a[168:171], v10 offset:20480
    ds_read_b128 a[172:175], v11 offset:20480
    v_mfma_f32_16x16x32_bf16 v[156:159], v[224:227], a[192:195], v[156:159]
    v_exp_f32 v218, v218
    v_mfma_f32_16x16x32_bf16 v[160:163], v[224:227], a[196:199], v[160:163]
    buffer_load_dwordx4 v24, s[20:23], s60 offen lds
    v_mfma_f32_16x16x32_bf16 v[164:167], v[224:227], a[200:203], v[164:167]
    v_exp_f32 v219, v219
    v_mfma_f32_16x16x32_bf16 v[240:243], v[224:227], a[204:207], v[240:243]
    v_cvt_pk_bf16_f32 v228, v216, v217
    v_cvt_pk_bf16_f32 v229, v218, v219
    v_mfma_f32_16x16x32_bf16 v[72:75], a[176:179], v[224:227], v[72:75]
    v_exp_f32 v220, v220
    v_mfma_f32_16x16x32_bf16 v[76:79], a[180:183], v[224:227], v[76:79]
    s_waitcnt lgkmcnt(0)
    buffer_load_dwordx4 v25, s[20:23], s60 offen offset:1024 lds
    v_mfma_f32_16x16x32_bf16 v[208:211], a[144:147], a[0:3], v[184:187]
    v_exp_f32 v221, v221
    v_mfma_f32_16x16x32_bf16 v[208:211], a[148:151], a[4:7], v[208:211]
    buffer_load_dwordx4 v24, s[20:23], s60 offen offset:2048 lds
    v_mfma_f32_16x16x32_bf16 v[208:211], a[152:155], a[8:11], v[208:211]
    s_bfe_u32 s62, s42, 0x40004
    v_exp_f32 v222, v222
    v_mfma_f32_16x16x32_bf16 v[208:211], a[156:159], a[12:15], v[208:211]
    buffer_load_dwordx4 v25, s[20:23], s60 offen offset:3072 lds
    v_mfma_f32_16x16x32_bf16 v[212:215], a[160:163], a[0:3], v[184:187]
    s_mul_i32 s62, s62, 0x2000
    v_exp_f32 v223, v223
    v_mfma_f32_16x16x32_bf16 v[212:215], a[164:167], a[4:7], v[212:215]
    s_add_u32 s62, s62, s44
    v_cvt_pk_bf16_f32 v230, v220, v221
    v_cvt_pk_bf16_f32 v231, v222, v223
    v_mfma_f32_16x16x32_bf16 v[212:215], a[168:171], a[8:11], v[212:215]
    s_waitcnt vmcnt(12)
    v_mfma_f32_16x16x32_bf16 v[212:215], a[172:175], a[12:15], v[212:215]
    s_add_u32 m0, s33, 0x3000
    v_exp_f32 v208, v208
    v_smfmac_f32_16x16x64_bf16 v[252:255], a[240:243], v[224:231], v6
    buffer_load_dwordx4 v24, s[20:23], s61 offen lds
    v_mfma_f32_16x16x32_bf16 v[232:235], v[228:231], a[184:187], v[232:235]
    s_and_b32 s62, s62, 0x1ffff
    v_exp_f32 v209, v209
    v_mfma_f32_16x16x32_bf16 v[168:171], v[228:231], a[188:191], v[168:171]
    s_add_u32 s63, s62, 0x1000
    ds_read_b64_tr_b16 a[184:185], v14 offset:24576
    ds_read_b64_tr_b16 a[186:187], v14 offset:28672
    v_mfma_f32_16x16x32_bf16 v[172:175], v[228:231], a[192:195], v[172:175]
    v_exp_f32 v210, v210
    v_mfma_f32_16x16x32_bf16 v[176:179], v[228:231], a[196:199], v[176:179]
    ds_read_b64_tr_b16 a[188:189], v15 offset:24576
    ds_read_b64_tr_b16 a[190:191], v15 offset:28672
    buffer_load_dwordx4 v25, s[20:23], s61 offen offset:1024 lds
    v_mfma_f32_16x16x32_bf16 v[180:183], v[228:231], a[200:203], v[180:183]
    v_exp_f32 v211, v211
    v_mfma_f32_16x16x32_bf16 v[248:251], v[228:231], a[204:207], v[248:251]
    v_cvt_pk_bf16_f32 v224, v208, v209
    v_cvt_pk_bf16_f32 v225, v210, v211
    v_mfma_f32_16x16x32_bf16 v[80:83], a[176:179], v[228:231], v[80:83]
    v_exp_f32 v212, v212
    v_mfma_f32_16x16x32_bf16 v[84:87], a[180:183], v[228:231], v[84:87]
    ds_read_b64_tr_b16 a[192:193], v16 offset:24576
    ds_read_b64_tr_b16 a[194:195], v16 offset:28672
    v_mfma_f32_16x16x32_bf16 v[216:219], a[144:147], a[16:19], v[188:191]
    v_exp_f32 v213, v213
    v_mfma_f32_16x16x32_bf16 v[216:219], a[148:151], a[20:23], v[216:219]
    ds_read_b64_tr_b16 a[196:197], v17 offset:24576
    ds_read_b64_tr_b16 a[198:199], v17 offset:28672
    v_mfma_f32_16x16x32_bf16 v[216:219], a[152:155], a[24:27], v[216:219]
    v_exp_f32 v214, v214
    v_mfma_f32_16x16x32_bf16 v[216:219], a[156:159], a[28:31], v[216:219]
    ds_read_b64_tr_b16 a[200:201], v18 offset:24576
    ds_read_b64_tr_b16 a[202:203], v18 offset:28672
    v_mfma_f32_16x16x32_bf16 v[220:223], a[160:163], a[16:19], v[188:191]
    v_exp_f32 v215, v215
    v_mfma_f32_16x16x32_bf16 v[220:223], a[164:167], a[20:23], v[220:223]
    v_cvt_pk_bf16_f32 v226, v212, v213
    v_cvt_pk_bf16_f32 v227, v214, v215
    v_mfma_f32_16x16x32_bf16 v[220:223], a[168:171], a[24:27], v[220:223]
    ds_read_b64_tr_b16 a[204:205], v19 offset:24576
    ds_read_b64_tr_b16 a[206:207], v19 offset:28672
    ds_read_b64_tr_b16 a[176:177], v12 offset:24576
    v_mfma_f32_16x16x32_bf16 v[220:223], a[172:175], a[28:31], v[220:223]
    ds_read_b64_tr_b16 a[178:179], v12 offset:28672
    v_exp_f32 v216, v216
    s_waitcnt lgkmcnt(6)
    v_mfma_f32_16x16x32_bf16 a[96:99], a[184:187], v[224:227], a[96:99]
    v_exp_f32 v217, v217
    v_mfma_f32_16x16x32_bf16 v[88:91], v[224:227], a[188:191], v[88:91]
    ds_read_b64_tr_b16 a[180:181], v13 offset:24576
    ds_read_b64_tr_b16 a[182:183], v13 offset:28672
    v_mfma_f32_16x16x32_bf16 v[92:95], v[224:227], a[192:195], v[92:95]
    v_exp_f32 v218, v218
    v_mfma_f32_16x16x32_bf16 v[96:99], v[224:227], a[196:199], v[96:99]
    s_waitcnt lgkmcnt(0)
    buffer_load_dwordx4 v24, s[20:23], s61 offen offset:2048 lds
    v_mfma_f32_16x16x32_bf16 v[100:103], v[224:227], a[200:203], v[100:103]
    v_exp_f32 v219, v219
    v_mfma_f32_16x16x32_bf16 a[100:103], a[204:207], v[224:227], a[100:103]
    v_cvt_pk_bf16_f32 v228, v216, v217
    v_cvt_pk_bf16_f32 v229, v218, v219
    v_mfma_f32_16x16x32_bf16 v[40:43], a[176:179], v[224:227], v[40:43]
    v_exp_f32 v220, v220
    v_mfma_f32_16x16x32_bf16 v[44:47], a[180:183], v[224:227], v[44:47]
    buffer_load_dwordx4 v25, s[20:23], s61 offen offset:3072 lds
    v_mfma_f32_16x16x32_bf16 v[208:211], a[144:147], a[32:35], v[192:195]
    v_exp_f32 v221, v221
    v_mfma_f32_16x16x32_bf16 v[208:211], a[148:151], a[36:39], v[208:211]
    v_mfma_f32_16x16x32_bf16 v[208:211], a[152:155], a[40:43], v[208:211]
    v_exp_f32 v222, v222
    v_mfma_f32_16x16x32_bf16 v[208:211], a[156:159], a[44:47], v[208:211]
    v_mfma_f32_16x16x32_bf16 v[212:215], a[160:163], a[32:35], v[192:195]
    v_exp_f32 v223, v223
    v_mfma_f32_16x16x32_bf16 v[212:215], a[164:167], a[36:39], v[212:215]
    v_cvt_pk_bf16_f32 v230, v220, v221
    v_cvt_pk_bf16_f32 v231, v222, v223
    v_mfma_f32_16x16x32_bf16 v[212:215], a[168:171], a[40:43], v[212:215]
    v_mfma_f32_16x16x32_bf16 v[212:215], a[172:175], a[44:47], v[212:215]
    v_exp_f32 v208, v208
    v_smfmac_f32_16x16x64_bf16 v[236:239], a[240:243], v[224:231], v6
    v_mfma_f32_16x16x32_bf16 a[104:107], a[184:187], v[228:231], a[104:107]
    v_exp_f32 v209, v209
    v_mfma_f32_16x16x32_bf16 v[104:107], v[228:231], a[188:191], v[104:107]
    v_mfma_f32_16x16x32_bf16 v[108:111], v[228:231], a[192:195], v[108:111]
    v_exp_f32 v210, v210
    v_mfma_f32_16x16x32_bf16 v[112:115], v[228:231], a[196:199], v[112:115]
    v_mfma_f32_16x16x32_bf16 v[116:119], v[228:231], a[200:203], v[116:119]
    v_exp_f32 v211, v211
    v_mfma_f32_16x16x32_bf16 a[108:111], a[204:207], v[228:231], a[108:111]
    v_cvt_pk_bf16_f32 v224, v208, v209
    v_cvt_pk_bf16_f32 v225, v210, v211
    v_mfma_f32_16x16x32_bf16 v[48:51], a[176:179], v[228:231], v[48:51]
    v_exp_f32 v212, v212
    v_mfma_f32_16x16x32_bf16 v[52:55], a[180:183], v[228:231], v[52:55]
    v_mfma_f32_16x16x32_bf16 v[216:219], a[144:147], a[48:51], v[196:199]
    v_exp_f32 v213, v213
    v_mfma_f32_16x16x32_bf16 v[216:219], a[148:151], a[52:55], v[216:219]
    v_mfma_f32_16x16x32_bf16 v[216:219], a[152:155], a[56:59], v[216:219]
    v_exp_f32 v214, v214
    v_mfma_f32_16x16x32_bf16 v[216:219], a[156:159], a[60:63], v[216:219]
    v_mfma_f32_16x16x32_bf16 v[220:223], a[160:163], a[48:51], v[196:199]
    v_exp_f32 v215, v215
    v_mfma_f32_16x16x32_bf16 v[220:223], a[164:167], a[52:55], v[220:223]
    v_cvt_pk_bf16_f32 v226, v212, v213
    v_cvt_pk_bf16_f32 v227, v214, v215
    v_mfma_f32_16x16x32_bf16 v[220:223], a[168:171], a[56:59], v[220:223]
    v_mfma_f32_16x16x32_bf16 v[220:223], a[172:175], a[60:63], v[220:223]
    v_exp_f32 v216, v216
    v_mfma_f32_16x16x32_bf16 a[112:115], a[184:187], v[224:227], a[112:115]
    s_add_u32 m0, s33, 0x4000
    v_exp_f32 v217, v217
    v_mfma_f32_16x16x32_bf16 v[120:123], v[224:227], a[188:191], v[120:123]
    buffer_load_dwordx4 v20, s[16:19], s62 offen lds
    v_mfma_f32_16x16x32_bf16 v[124:127], v[224:227], a[192:195], v[124:127]
    v_exp_f32 v218, v218
    v_mfma_f32_16x16x32_bf16 v[128:131], v[224:227], a[196:199], v[128:131]
    buffer_load_dwordx4 v21, s[16:19], s62 offen offset:1024 lds
    v_mfma_f32_16x16x32_bf16 v[132:135], v[224:227], a[200:203], v[132:135]
    v_exp_f32 v219, v219
    v_mfma_f32_16x16x32_bf16 a[116:119], a[204:207], v[224:227], a[116:119]
    v_cvt_pk_bf16_f32 v228, v216, v217
    v_cvt_pk_bf16_f32 v229, v218, v219
    v_mfma_f32_16x16x32_bf16 v[56:59], a[176:179], v[224:227], v[56:59]
    v_exp_f32 v220, v220
    v_mfma_f32_16x16x32_bf16 v[60:63], a[180:183], v[224:227], v[60:63]
    buffer_load_dwordx4 v22, s[16:19], s62 offen offset:2048 lds
    v_mfma_f32_16x16x32_bf16 v[208:211], a[144:147], a[64:67], v[200:203]
    v_exp_f32 v221, v221
    v_mfma_f32_16x16x32_bf16 v[208:211], a[148:151], a[68:71], v[208:211]
    v_mfma_f32_16x16x32_bf16 v[208:211], a[152:155], a[72:75], v[208:211]
    v_exp_f32 v222, v222
    v_mfma_f32_16x16x32_bf16 v[208:211], a[156:159], a[76:79], v[208:211]
    buffer_load_dwordx4 v23, s[16:19], s62 offen offset:3072 lds
    v_mfma_f32_16x16x32_bf16 v[212:215], a[160:163], a[64:67], v[200:203]
    v_exp_f32 v223, v223
    v_mfma_f32_16x16x32_bf16 v[212:215], a[164:167], a[68:71], v[212:215]
    v_cvt_pk_bf16_f32 v230, v220, v221
    v_cvt_pk_bf16_f32 v231, v222, v223
    v_mfma_f32_16x16x32_bf16 v[212:215], a[168:171], a[72:75], v[212:215]
    v_mfma_f32_16x16x32_bf16 v[212:215], a[172:175], a[76:79], v[212:215]
    s_add_u32 m0, s33, 0x5000
    v_exp_f32 v208, v208
    v_smfmac_f32_16x16x64_bf16 v[244:247], a[240:243], v[224:231], v6
    v_mfma_f32_16x16x32_bf16 a[120:123], a[184:187], v[228:231], a[120:123]
    s_bfe_u32 s64, s42, 0x40008
    v_exp_f32 v209, v209
    v_mfma_f32_16x16x32_bf16 v[136:139], v[228:231], a[188:191], v[136:139]
    buffer_load_dwordx4 v20, s[16:19], s63 offen lds
    v_mfma_f32_16x16x32_bf16 v[140:143], v[228:231], a[192:195], v[140:143]
    s_mul_i32 s64, s64, 0x2000
    v_exp_f32 v210, v210
    v_mfma_f32_16x16x32_bf16 v[144:147], v[228:231], a[196:199], v[144:147]
    buffer_load_dwordx4 v21, s[16:19], s63 offen offset:1024 lds
    v_mfma_f32_16x16x32_bf16 v[148:151], v[228:231], a[200:203], v[148:151]
    s_add_u32 s64, s64, s44
    v_exp_f32 v211, v211
    v_mfma_f32_16x16x32_bf16 a[124:127], a[204:207], v[228:231], a[124:127]
    s_and_b32 s64, s64, 0x1ffff
    v_cvt_pk_bf16_f32 v224, v208, v209
    v_cvt_pk_bf16_f32 v225, v210, v211
    v_mfma_f32_16x16x32_bf16 v[64:67], a[176:179], v[228:231], v[64:67]
    s_waitcnt vmcnt(14)
    v_exp_f32 v212, v212
    v_mfma_f32_16x16x32_bf16 v[68:71], a[180:183], v[228:231], v[68:71]
    buffer_load_dwordx4 v22, s[16:19], s63 offen offset:2048 lds
    v_mfma_f32_16x16x32_bf16 v[216:219], a[144:147], a[80:83], v[204:207]
    s_add_u32 s65, s64, 0x1000
    v_exp_f32 v213, v213
    v_mfma_f32_16x16x32_bf16 v[216:219], a[148:151], a[84:87], v[216:219]
L_t4:
    s_cbranch_vccnz L_tr
    ds_read_b128 a[144:147], v8
    ds_read_b128 a[148:151], v9
    v_mfma_f32_16x16x32_bf16 v[216:219], a[152:155], a[88:91], v[216:219]
    v_exp_f32 v214, v214
    v_mfma_f32_16x16x32_bf16 v[216:219], a[156:159], a[92:95], v[216:219]
    ds_read_b128 a[152:155], v10
    ds_read_b128 a[156:159], v11
    v_mfma_f32_16x16x32_bf16 v[220:223], a[160:163], a[80:83], v[204:207]
    v_exp_f32 v215, v215
    v_mfma_f32_16x16x32_bf16 v[220:223], a[164:167], a[84:87], v[220:223]
    v_cvt_pk_bf16_f32 v226, v212, v213
    v_cvt_pk_bf16_f32 v227, v214, v215
    v_mfma_f32_16x16x32_bf16 v[220:223], a[168:171], a[88:91], v[220:223]
    ds_read_b128 a[160:163], v8 offset:4096
    ds_read_b128 a[164:167], v9 offset:4096
    v_mfma_f32_16x16x32_bf16 v[220:223], a[172:175], a[92:95], v[220:223]
    v_exp_f32 v216, v216
    v_mfma_f32_16x16x32_bf16 a[128:131], a[184:187], v[224:227], a[128:131]
    v_exp_f32 v217, v217
    v_mfma_f32_16x16x32_bf16 v[152:155], v[224:227], a[188:191], v[152:155]
    ds_read_b128 a[168:171], v10 offset:4096
    ds_read_b128 a[172:175], v11 offset:4096
    v_mfma_f32_16x16x32_bf16 v[156:159], v[224:227], a[192:195], v[156:159]
    v_exp_f32 v218, v218
    v_mfma_f32_16x16x32_bf16 v[160:163], v[224:227], a[196:199], v[160:163]
    buffer_load_dwordx4 v23, s[16:19], s63 offen offset:3072 lds
    v_mfma_f32_16x16x32_bf16 v[164:167], v[224:227], a[200:203], v[164:167]
    s_add_u32 m0, s33, 0x6000
    v_exp_f32 v219, v219
    v_mfma_f32_16x16x32_bf16 v[240:243], v[224:227], a[204:207], v[240:243]
    v_cvt_pk_bf16_f32 v228, v216, v217
    v_cvt_pk_bf16_f32 v229, v218, v219
    v_mfma_f32_16x16x32_bf16 v[72:75], a[176:179], v[224:227], v[72:75]
    v_exp_f32 v220, v220
    v_mfma_f32_16x16x32_bf16 v[76:79], a[180:183], v[224:227], v[76:79]
    s_waitcnt lgkmcnt(0)
    buffer_load_dwordx4 v24, s[20:23], s62 offen lds
    v_mfma_f32_16x16x32_bf16 v[208:211], a[144:147], a[0:3], v[184:187]
    v_exp_f32 v221, v221
    v_mfma_f32_16x16x32_bf16 v[208:211], a[148:151], a[4:7], v[208:211]
    buffer_load_dwordx4 v25, s[20:23], s62 offen offset:1024 lds
    v_mfma_f32_16x16x32_bf16 v[208:211], a[152:155], a[8:11], v[208:211]
    v_exp_f32 v222, v222
    v_mfma_f32_16x16x32_bf16 v[208:211], a[156:159], a[12:15], v[208:211]
    buffer_load_dwordx4 v24, s[20:23], s62 offen offset:2048 lds
    v_mfma_f32_16x16x32_bf16 v[212:215], a[160:163], a[0:3], v[184:187]
    v_exp_f32 v223, v223
    v_mfma_f32_16x16x32_bf16 v[212:215], a[164:167], a[4:7], v[212:215]
    v_cvt_pk_bf16_f32 v230, v220, v221
    v_cvt_pk_bf16_f32 v231, v222, v223
    v_mfma_f32_16x16x32_bf16 v[212:215], a[168:171], a[8:11], v[212:215]
    s_waitcnt vmcnt(11)
    buffer_load_dwordx4 v25, s[20:23], s62 offen offset:3072 lds
    v_mfma_f32_16x16x32_bf16 v[212:215], a[172:175], a[12:15], v[212:215]
    s_add_u32 m0, s33, 0x7000
    v_exp_f32 v208, v208
    v_smfmac_f32_16x16x64_bf16 v[252:255], a[240:243], v[224:231], v6
    buffer_load_dwordx4 v24, s[20:23], s63 offen lds
    v_mfma_f32_16x16x32_bf16 v[232:235], v[228:231], a[184:187], v[232:235]
    v_exp_f32 v209, v209
    v_mfma_f32_16x16x32_bf16 v[168:171], v[228:231], a[188:191], v[168:171]
    ds_read_b64_tr_b16 a[184:185], v14 offset:8192
    ds_read_b64_tr_b16 a[186:187], v14 offset:12288
    v_mfma_f32_16x16x32_bf16 v[172:175], v[228:231], a[192:195], v[172:175]
    v_exp_f32 v210, v210
    v_mfma_f32_16x16x32_bf16 v[176:179], v[228:231], a[196:199], v[176:179]
    ds_read_b64_tr_b16 a[188:189], v15 offset:8192
    ds_read_b64_tr_b16 a[190:191], v15 offset:12288
    buffer_load_dwordx4 v25, s[20:23], s63 offen offset:1024 lds
    v_mfma_f32_16x16x32_bf16 v[180:183], v[228:231], a[200:203], v[180:183]
    v_exp_f32 v211, v211
    v_mfma_f32_16x16x32_bf16 v[248:251], v[228:231], a[204:207], v[248:251]
    v_cvt_pk_bf16_f32 v224, v208, v209
    v_cvt_pk_bf16_f32 v225, v210, v211
    v_mfma_f32_16x16x32_bf16 v[80:83], a[176:179], v[228:231], v[80:83]
    v_exp_f32 v212, v212
    v_mfma_f32_16x16x32_bf16 v[84:87], a[180:183], v[228:231], v[84:87]
    ds_read_b64_tr_b16 a[192:193], v16 offset:8192
    ds_read_b64_tr_b16 a[194:195], v16 offset:12288
    v_mfma_f32_16x16x32_bf16 v[216:219], a[144:147], a[16:19], v[188:191]
    v_exp_f32 v213, v213
    v_mfma_f32_16x16x32_bf16 v[216:219], a[148:151], a[20:23], v[216:219]
    ds_read_b64_tr_b16 a[196:197], v17 offset:8192
    ds_read_b64_tr_b16 a[198:199], v17 offset:12288
    v_mfma_f32_16x16x32_bf16 v[216:219], a[152:155], a[24:27], v[216:219]
    v_exp_f32 v214, v214
    v_mfma_f32_16x16x32_bf16 v[216:219], a[156:159], a[28:31], v[216:219]
    ds_read_b64_tr_b16 a[200:201], v18 offset:8192
    ds_read_b64_tr_b16 a[202:203], v18 offset:12288
    v_mfma_f32_16x16x32_bf16 v[220:223], a[160:163], a[16:19], v[188:191]
    v_exp_f32 v215, v215
    v_mfma_f32_16x16x32_bf16 v[220:223], a[164:167], a[20:23], v[220:223]
    v_cvt_pk_bf16_f32 v226, v212, v213
    v_cvt_pk_bf16_f32 v227, v214, v215
    v_mfma_f32_16x16x32_bf16 v[220:223], a[168:171], a[24:27], v[220:223]
    ds_read_b64_tr_b16 a[204:205], v19 offset:8192
    ds_read_b64_tr_b16 a[206:207], v19 offset:12288
    ds_read_b64_tr_b16 a[176:177], v12 offset:8192
    v_mfma_f32_16x16x32_bf16 v[220:223], a[172:175], a[28:31], v[220:223]
    ds_read_b64_tr_b16 a[178:179], v12 offset:12288
    v_exp_f32 v216, v216
    s_waitcnt lgkmcnt(6)
    v_mfma_f32_16x16x32_bf16 a[96:99], a[184:187], v[224:227], a[96:99]
    v_exp_f32 v217, v217
    v_mfma_f32_16x16x32_bf16 v[88:91], v[224:227], a[188:191], v[88:91]
    ds_read_b64_tr_b16 a[180:181], v13 offset:8192
    ds_read_b64_tr_b16 a[182:183], v13 offset:12288
    v_mfma_f32_16x16x32_bf16 v[92:95], v[224:227], a[192:195], v[92:95]
    v_exp_f32 v218, v218
    v_mfma_f32_16x16x32_bf16 v[96:99], v[224:227], a[196:199], v[96:99]
    s_waitcnt lgkmcnt(0)
    buffer_load_dwordx4 v24, s[20:23], s63 offen offset:2048 lds
    v_mfma_f32_16x16x32_bf16 v[100:103], v[224:227], a[200:203], v[100:103]
    v_exp_f32 v219, v219
    v_mfma_f32_16x16x32_bf16 a[100:103], a[204:207], v[224:227], a[100:103]
    v_cvt_pk_bf16_f32 v228, v216, v217
    v_cvt_pk_bf16_f32 v229, v218, v219
    v_mfma_f32_16x16x32_bf16 v[40:43], a[176:179], v[224:227], v[40:43]
    v_exp_f32 v220, v220
    v_mfma_f32_16x16x32_bf16 v[44:47], a[180:183], v[224:227], v[44:47]
    buffer_load_dwordx4 v25, s[20:23], s63 offen offset:3072 lds
    v_mfma_f32_16x16x32_bf16 v[208:211], a[144:147], a[32:35], v[192:195]
    s_mov_b32 m0, s33
    v_exp_f32 v221, v221
    v_mfma_f32_16x16x32_bf16 v[208:211], a[148:151], a[36:39], v[208:211]
    buffer_load_dwordx4 v20, s[16:19], s64 offen lds
    v_mfma_f32_16x16x32_bf16 v[208:211], a[152:155], a[40:43], v[208:211]
    v_exp_f32 v222, v222
    v_mfma_f32_16x16x32_bf16 v[208:211], a[156:159], a[44:47], v[208:211]
    buffer_load_dwordx4 v21, s[16:19], s64 offen offset:1024 lds
    v_mfma_f32_16x16x32_bf16 v[212:215], a[160:163], a[32:35], v[192:195]
    v_exp_f32 v223, v223
    v_mfma_f32_16x16x32_bf16 v[212:215], a[164:167], a[36:39], v[212:215]
    v_cvt_pk_bf16_f32 v230, v220, v221
    v_cvt_pk_bf16_f32 v231, v222, v223
    v_mfma_f32_16x16x32_bf16 v[212:215], a[168:171], a[40:43], v[212:215]
    buffer_load_dwordx4 v22, s[16:19], s64 offen offset:2048 lds
    v_mfma_f32_16x16x32_bf16 v[212:215], a[172:175], a[44:47], v[212:215]
    v_exp_f32 v208, v208
    v_smfmac_f32_16x16x64_bf16 v[236:239], a[240:243], v[224:231], v6
    v_mfma_f32_16x16x32_bf16 a[104:107], a[184:187], v[228:231], a[104:107]
    v_exp_f32 v209, v209
    v_mfma_f32_16x16x32_bf16 v[104:107], v[228:231], a[188:191], v[104:107]
    buffer_load_dwordx4 v23, s[16:19], s64 offen offset:3072 lds
    v_mfma_f32_16x16x32_bf16 v[108:111], v[228:231], a[192:195], v[108:111]
    s_add_u32 m0, s33, 0x1000
    v_exp_f32 v210, v210
    v_mfma_f32_16x16x32_bf16 v[112:115], v[228:231], a[196:199], v[112:115]
    buffer_load_dwordx4 v20, s[16:19], s65 offen lds
    v_mfma_f32_16x16x32_bf16 v[116:119], v[228:231], a[200:203], v[116:119]
    v_exp_f32 v211, v211
    v_mfma_f32_16x16x32_bf16 a[108:111], a[204:207], v[228:231], a[108:111]
    v_cvt_pk_bf16_f32 v224, v208, v209
    v_cvt_pk_bf16_f32 v225, v210, v211
    v_mfma_f32_16x16x32_bf16 v[48:51], a[176:179], v[228:231], v[48:51]
    v_exp_f32 v212, v212
    v_mfma_f32_16x16x32_bf16 v[52:55], a[180:183], v[228:231], v[52:55]
    buffer_load_dwordx4 v21, s[16:19], s65 offen offset:1024 lds
    v_mfma_f32_16x16x32_bf16 v[216:219], a[144:147], a[48:51], v[196:199]
    v_exp_f32 v213, v213
    v_mfma_f32_16x16x32_bf16 v[216:219], a[148:151], a[52:55], v[216:219]
    buffer_load_dwordx4 v22, s[16:19], s65 offen offset:2048 lds
    v_mfma_f32_16x16x32_bf16 v[216:219], a[152:155], a[56:59], v[216:219]
    v_exp_f32 v214, v214
    v_mfma_f32_16x16x32_bf16 v[216:219], a[156:159], a[60:63], v[216:219]
    v_mfma_f32_16x16x32_bf16 v[220:223], a[160:163], a[48:51], v[196:199]
    v_exp_f32 v215, v215
    v_mfma_f32_16x16x32_bf16 v[220:223], a[164:167], a[52:55], v[220:223]
    v_cvt_pk_bf16_f32 v226, v212, v213
    v_cvt_pk_bf16_f32 v227, v214, v215
    v_mfma_f32_16x16x32_bf16 v[220:223], a[168:171], a[56:59], v[220:223]
    buffer_load_dwordx4 v23, s[16:19], s65 offen offset:3072 lds
    v_mfma_f32_16x16x32_bf16 v[220:223], a[172:175], a[60:63], v[220:223]
    v_exp_f32 v216, v216
    v_mfma_f32_16x16x32_bf16 a[112:115], a[184:187], v[224:227], a[112:115]
    v_exp_f32 v217, v217
    v_mfma_f32_16x16x32_bf16 v[120:123], v[224:227], a[188:191], v[120:123]
    v_mfma_f32_16x16x32_bf16 v[124:127], v[224:227], a[192:195], v[124:127]
    v_exp_f32 v218, v218
    v_mfma_f32_16x16x32_bf16 v[128:131], v[224:227], a[196:199], v[128:131]
    v_mfma_f32_16x16x32_bf16 v[132:135], v[224:227], a[200:203], v[132:135]
    v_exp_f32 v219, v219
    v_mfma_f32_16x16x32_bf16 a[116:119], a[204:207], v[224:227], a[116:119]
    v_cvt_pk_bf16_f32 v228, v216, v217
    v_cvt_pk_bf16_f32 v229, v218, v219
    v_mfma_f32_16x16x32_bf16 v[56:59], a[176:179], v[224:227], v[56:59]
    v_exp_f32 v220, v220
    v_mfma_f32_16x16x32_bf16 v[60:63], a[180:183], v[224:227], v[60:63]
    v_mfma_f32_16x16x32_bf16 v[208:211], a[144:147], a[64:67], v[200:203]
    v_exp_f32 v221, v221
    v_mfma_f32_16x16x32_bf16 v[208:211], a[148:151], a[68:71], v[208:211]
    v_mfma_f32_16x16x32_bf16 v[208:211], a[152:155], a[72:75], v[208:211]
    v_exp_f32 v222, v222
    v_mfma_f32_16x16x32_bf16 v[208:211], a[156:159], a[76:79], v[208:211]
    v_mfma_f32_16x16x32_bf16 v[212:215], a[160:163], a[64:67], v[200:203]
    v_exp_f32 v223, v223
    v_mfma_f32_16x16x32_bf16 v[212:215], a[164:167], a[68:71], v[212:215]
    v_cvt_pk_bf16_f32 v230, v220, v221
    v_cvt_pk_bf16_f32 v231, v222, v223
    v_mfma_f32_16x16x32_bf16 v[212:215], a[168:171], a[72:75], v[212:215]
    v_mfma_f32_16x16x32_bf16 v[212:215], a[172:175], a[76:79], v[212:215]
    v_exp_f32 v208, v208
    v_smfmac_f32_16x16x64_bf16 v[244:247], a[240:243], v[224:231], v6
    v_mfma_f32_16x16x32_bf16 a[120:123], a[184:187], v[228:231], a[120:123]
    v_exp_f32 v209, v209
    v_mfma_f32_16x16x32_bf16 v[136:139], v[228:231], a[188:191], v[136:139]
    v_mfma_f32_16x16x32_bf16 v[140:143], v[228:231], a[192:195], v[140:143]
    v_exp_f32 v210, v210
    v_mfma_f32_16x16x32_bf16 v[144:147], v[228:231], a[196:199], v[144:147]
    v_mfma_f32_16x16x32_bf16 v[148:151], v[228:231], a[200:203], v[148:151]
    v_exp_f32 v211, v211
    v_mfma_f32_16x16x32_bf16 a[124:127], a[204:207], v[228:231], a[124:127]
    v_cvt_pk_bf16_f32 v224, v208, v209
    v_cvt_pk_bf16_f32 v225, v210, v211
    v_mfma_f32_16x16x32_bf16 v[64:67], a[176:179], v[228:231], v[64:67]
    s_waitcnt vmcnt(16)
    v_exp_f32 v212, v212
    v_mfma_f32_16x16x32_bf16 v[68:71], a[180:183], v[228:231], v[68:71]
    v_mfma_f32_16x16x32_bf16 v[216:219], a[144:147], a[80:83], v[204:207]
    v_exp_f32 v213, v213
    v_mfma_f32_16x16x32_bf16 v[216:219], a[148:151], a[84:87], v[216:219]
    ds_read_b128 a[144:147], v8 offset:16384
    ds_read_b128 a[148:151], v9 offset:16384
    v_mfma_f32_16x16x32_bf16 v[216:219], a[152:155], a[88:91], v[216:219]
    v_exp_f32 v214, v214
    v_mfma_f32_16x16x32_bf16 v[216:219], a[156:159], a[92:95], v[216:219]
    ds_read_b128 a[152:155], v10 offset:16384
    ds_read_b128 a[156:159], v11 offset:16384
    v_mfma_f32_16x16x32_bf16 v[220:223], a[160:163], a[80:83], v[204:207]
    v_exp_f32 v215, v215
    v_mfma_f32_16x16x32_bf16 v[220:223], a[164:167], a[84:87], v[220:223]
    v_cvt_pk_bf16_f32 v226, v212, v213
    v_cvt_pk_bf16_f32 v227, v214, v215
    v_mfma_f32_16x16x32_bf16 v[220:223], a[168:171], a[88:91], v[220:223]
    ds_read_b128 a[160:163], v8 offset:20480
    ds_read_b128 a[164:167], v9 offset:20480
    v_mfma_f32_16x16x32_bf16 v[220:223], a[172:175], a[92:95], v[220:223]
    v_exp_f32 v216, v216
    v_mfma_f32_16x16x32_bf16 a[128:131], a[184:187], v[224:227], a[128:131]
    s_add_u32 m0, s33, 0x2000
    v_exp_f32 v217, v217
    v_mfma_f32_16x16x32_bf16 v[152:155], v[224:227], a[188:191], v[152:155]
    ds_read_b128 a[168:171], v10 offset:20480
    ds_read_b128 a[172:175], v11 offset:20480
    v_mfma_f32_16x16x32_bf16 v[156:159], v[224:227], a[192:195], v[156:159]
    v_exp_f32 v218, v218
    v_mfma_f32_16x16x32_bf16 v[160:163], v[224:227], a[196:199], v[160:163]
    buffer_load_dwordx4 v24, s[20:23], s64 offen lds
    v_mfma_f32_16x16x32_bf16 v[164:167], v[224:227], a[200:203], v[164:167]
    v_exp_f32 v219, v219
    v_mfma_f32_16x16x32_bf16 v[240:243], v[224:227], a[204:207], v[240:243]
    v_cvt_pk_bf16_f32 v228, v216, v217
    v_cvt_pk_bf16_f32 v229, v218, v219
    v_mfma_f32_16x16x32_bf16 v[72:75], a[176:179], v[224:227], v[72:75]
    v_exp_f32 v220, v220
    v_mfma_f32_16x16x32_bf16 v[76:79], a[180:183], v[224:227], v[76:79]
    s_waitcnt lgkmcnt(0)
    buffer_load_dwordx4 v25, s[20:23], s64 offen offset:1024 lds
    v_mfma_f32_16x16x32_bf16 v[208:211], a[144:147], a[0:3], v[184:187]
    v_exp_f32 v221, v221
    v_mfma_f32_16x16x32_bf16 v[208:211], a[148:151], a[4:7], v[208:211]
    buffer_load_dwordx4 v24, s[20:23], s64 offen offset:2048 lds
    v_mfma_f32_16x16x32_bf16 v[208:211], a[152:155], a[8:11], v[208:211]
    s_bfe_u32 s66, s42, 0x4000c
    v_exp_f32 v222, v222
    v_mfma_f32_16x16x32_bf16 v[208:211], a[156:159], a[12:15], v[208:211]
    buffer_load_dwordx4 v25, s[20:23], s64 offen offset:3072 lds
    v_mfma_f32_16x16x32_bf16 v[212:215], a[160:163], a[0:3], v[184:187]
    s_mul_i32 s66, s66, 0x2000
    v_exp_f32 v223, v223
    v_mfma_f32_16x16x32_bf16 v[212:215], a[164:167], a[4:7], v[212:215]
    s_add_u32 s66, s66, s44
    v_cvt_pk_bf16_f32 v230, v220, v221
    v_cvt_pk_bf16_f32 v231, v222, v223
    v_mfma_f32_16x16x32_bf16 v[212:215], a[168:171], a[8:11], v[212:215]
    s_waitcnt vmcnt(12)
    v_mfma_f32_16x16x32_bf16 v[212:215], a[172:175], a[12:15], v[212:215]
    s_add_u32 m0, s33, 0x3000
    v_exp_f32 v208, v208
    v_smfmac_f32_16x16x64_bf16 v[252:255], a[240:243], v[224:231], v6
    buffer_load_dwordx4 v24, s[20:23], s65 offen lds
    v_mfma_f32_16x16x32_bf16 v[232:235], v[228:231], a[184:187], v[232:235]
    s_and_b32 s66, s66, 0x1ffff
    v_exp_f32 v209, v209
    v_mfma_f32_16x16x32_bf16 v[168:171], v[228:231], a[188:191], v[168:171]
    s_add_u32 s67, s66, 0x1000
    ds_read_b64_tr_b16 a[184:185], v14 offset:24576
    ds_read_b64_tr_b16 a[186:187], v14 offset:28672
    v_mfma_f32_16x16x32_bf16 v[172:175], v[228:231], a[192:195], v[172:175]
    v_exp_f32 v210, v210
    v_mfma_f32_16x16x32_bf16 v[176:179], v[228:231], a[196:199], v[176:179]
    ds_read_b64_tr_b16 a[188:189], v15 offset:24576
    ds_read_b64_tr_b16 a[190:191], v15 offset:28672
    buffer_load_dwordx4 v25, s[20:23], s65 offen offset:1024 lds
    v_mfma_f32_16x16x32_bf16 v[180:183], v[228:231], a[200:203], v[180:183]
    v_exp_f32 v211, v211
    v_mfma_f32_16x16x32_bf16 v[248:251], v[228:231], a[204:207], v[248:251]
    v_cvt_pk_bf16_f32 v224, v208, v209
    v_cvt_pk_bf16_f32 v225, v210, v211
    v_mfma_f32_16x16x32_bf16 v[80:83], a[176:179], v[228:231], v[80:83]
    v_exp_f32 v212, v212
    v_mfma_f32_16x16x32_bf16 v[84:87], a[180:183], v[228:231], v[84:87]
    ds_read_b64_tr_b16 a[192:193], v16 offset:24576
    ds_read_b64_tr_b16 a[194:195], v16 offset:28672
    v_mfma_f32_16x16x32_bf16 v[216:219], a[144:147], a[16:19], v[188:191]
    v_exp_f32 v213, v213
    v_mfma_f32_16x16x32_bf16 v[216:219], a[148:151], a[20:23], v[216:219]
    ds_read_b64_tr_b16 a[196:197], v17 offset:24576
    ds_read_b64_tr_b16 a[198:199], v17 offset:28672
    v_mfma_f32_16x16x32_bf16 v[216:219], a[152:155], a[24:27], v[216:219]
    v_exp_f32 v214, v214
    v_mfma_f32_16x16x32_bf16 v[216:219], a[156:159], a[28:31], v[216:219]
    ds_read_b64_tr_b16 a[200:201], v18 offset:24576
    ds_read_b64_tr_b16 a[202:203], v18 offset:28672
    v_mfma_f32_16x16x32_bf16 v[220:223], a[160:163], a[16:19], v[188:191]
    v_exp_f32 v215, v215
    v_mfma_f32_16x16x32_bf16 v[220:223], a[164:167], a[20:23], v[220:223]
    v_cvt_pk_bf16_f32 v226, v212, v213
    v_cvt_pk_bf16_f32 v227, v214, v215
    v_mfma_f32_16x16x32_bf16 v[220:223], a[168:171], a[24:27], v[220:223]
    ds_read_b64_tr_b16 a[204:205], v19 offset:24576
    ds_read_b64_tr_b16 a[206:207], v19 offset:28672
    ds_read_b64_tr_b16 a[176:177], v12 offset:24576
    v_mfma_f32_16x16x32_bf16 v[220:223], a[172:175], a[28:31], v[220:223]
    ds_read_b64_tr_b16 a[178:179], v12 offset:28672
    v_exp_f32 v216, v216
    s_waitcnt lgkmcnt(6)
    v_mfma_f32_16x16x32_bf16 a[96:99], a[184:187], v[224:227], a[96:99]
    v_exp_f32 v217, v217
    v_mfma_f32_16x16x32_bf16 v[88:91], v[224:227], a[188:191], v[88:91]
    ds_read_b64_tr_b16 a[180:181], v13 offset:24576
    ds_read_b64_tr_b16 a[182:183], v13 offset:28672
    v_mfma_f32_16x16x32_bf16 v[92:95], v[224:227], a[192:195], v[92:95]
    v_exp_f32 v218, v218
    v_mfma_f32_16x16x32_bf16 v[96:99], v[224:227], a[196:199], v[96:99]
    s_waitcnt lgkmcnt(0)
    buffer_load_dwordx4 v24, s[20:23], s65 offen offset:2048 lds
    v_mfma_f32_16x16x32_bf16 v[100:103], v[224:227], a[200:203], v[100:103]
    v_exp_f32 v219, v219
    v_mfma_f32_16x16x32_bf16 a[100:103], a[204:207], v[224:227], a[100:103]
    v_cvt_pk_bf16_f32 v228, v216, v217
    v_cvt_pk_bf16_f32 v229, v218, v219
    v_mfma_f32_16x16x32_bf16 v[40:43], a[176:179], v[224:227], v[40:43]
    v_exp_f32 v220, v220
    v_mfma_f32_16x16x32_bf16 v[44:47], a[180:183], v[224:227], v[44:47]
    buffer_load_dwordx4 v25, s[20:23], s65 offen offset:3072 lds
    v_mfma_f32_16x16x32_bf16 v[208:211], a[144:147], a[32:35], v[192:195]
    v_exp_f32 v221, v221
    v_mfma_f32_16x16x32_bf16 v[208:211], a[148:151], a[36:39], v[208:211]
    v_mfma_f32_16x16x32_bf16 v[208:211], a[152:155], a[40:43], v[208:211]
    v_exp_f32 v222, v222
    v_mfma_f32_16x16x32_bf16 v[208:211], a[156:159], a[44:47], v[208:211]
    v_mfma_f32_16x16x32_bf16 v[212:215], a[160:163], a[32:35], v[192:195]
    v_exp_f32 v223, v223
    v_mfma_f32_16x16x32_bf16 v[212:215], a[164:167], a[36:39], v[212:215]
    v_cvt_pk_bf16_f32 v230, v220, v221
    v_cvt_pk_bf16_f32 v231, v222, v223
    v_mfma_f32_16x16x32_bf16 v[212:215], a[168:171], a[40:43], v[212:215]
    v_mfma_f32_16x16x32_bf16 v[212:215], a[172:175], a[44:47], v[212:215]
    v_exp_f32 v208, v208
    v_smfmac_f32_16x16x64_bf16 v[236:239], a[240:243], v[224:231], v6
    v_mfma_f32_16x16x32_bf16 a[104:107], a[184:187], v[228:231], a[104:107]
    v_exp_f32 v209, v209
    v_mfma_f32_16x16x32_bf16 v[104:107], v[228:231], a[188:191], v[104:107]
    v_mfma_f32_16x16x32_bf16 v[108:111], v[228:231], a[192:195], v[108:111]
    v_exp_f32 v210, v210
    v_mfma_f32_16x16x32_bf16 v[112:115], v[228:231], a[196:199], v[112:115]
    v_mfma_f32_16x16x32_bf16 v[116:119], v[228:231], a[200:203], v[116:119]
    v_exp_f32 v211, v211
    v_mfma_f32_16x16x32_bf16 a[108:111], a[204:207], v[228:231], a[108:111]
    v_cvt_pk_bf16_f32 v224, v208, v209
    v_cvt_pk_bf16_f32 v225, v210, v211
    v_mfma_f32_16x16x32_bf16 v[48:51], a[176:179], v[228:231], v[48:51]
    v_exp_f32 v212, v212
    v_mfma_f32_16x16x32_bf16 v[52:55], a[180:183], v[228:231], v[52:55]
    v_mfma_f32_16x16x32_bf16 v[216:219], a[144:147], a[48:51], v[196:199]
    v_exp_f32 v213, v213
    v_mfma_f32_16x16x32_bf16 v[216:219], a[148:151], a[52:55], v[216:219]
    v_mfma_f32_16x16x32_bf16 v[216:219], a[152:155], a[56:59], v[216:219]
    v_exp_f32 v214, v214
    v_mfma_f32_16x16x32_bf16 v[216:219], a[156:159], a[60:63], v[216:219]
    v_mfma_f32_16x16x32_bf16 v[220:223], a[160:163], a[48:51], v[196:199]
    v_exp_f32 v215, v215
    v_mfma_f32_16x16x32_bf16 v[220:223], a[164:167], a[52:55], v[220:223]
    v_cvt_pk_bf16_f32 v226, v212, v213
    v_cvt_pk_bf16_f32 v227, v214, v215
    v_mfma_f32_16x16x32_bf16 v[220:223], a[168:171], a[56:59], v[220:223]
    v_mfma_f32_16x16x32_bf16 v[220:223], a[172:175], a[60:63], v[220:223]
    v_exp_f32 v216, v216
    v_mfma_f32_16x16x32_bf16 a[112:115], a[184:187], v[224:227], a[112:115]
    s_add_u32 m0, s33, 0x4000
    v_exp_f32 v217, v217
    v_mfma_f32_16x16x32_bf16 v[120:123], v[224:227], a[188:191], v[120:123]
    buffer_load_dwordx4 v20, s[16:19], s66 offen lds
    v_mfma_f32_16x16x32_bf16 v[124:127], v[224:227], a[192:195], v[124:127]
    v_exp_f32 v218, v218
    v_mfma_f32_16x16x32_bf16 v[128:131], v[224:227], a[196:199], v[128:131]
    buffer_load_dwordx4 v21, s[16:19], s66 offen offset:1024 lds
    v_mfma_f32_16x16x32_bf16 v[132:135], v[224:227], a[200:203], v[132:135]
    v_exp_f32 v219, v219
    v_mfma_f32_16x16x32_bf16 a[116:119], a[204:207], v[224:227], a[116:119]
    v_cvt_pk_bf16_f32 v228, v216, v217
    v_cvt_pk_bf16_f32 v229, v218, v219
    v_mfma_f32_16x16x32_bf16 v[56:59], a[176:179], v[224:227], v[56:59]
    v_exp_f32 v220, v220
    v_mfma_f32_16x16x32_bf16 v[60:63], a[180:183], v[224:227], v[60:63]
    buffer_load_dwordx4 v22, s[16:19], s66 offen offset:2048 lds
    v_mfma_f32_16x16x32_bf16 v[208:211], a[144:147], a[64:67], v[200:203]
    v_exp_f32 v221, v221
    v_mfma_f32_16x16x32_bf16 v[208:211], a[148:151], a[68:71], v[208:211]
    v_mfma_f32_16x16x32_bf16 v[208:211], a[152:155], a[72:75], v[208:211]
    v_exp_f32 v222, v222
    v_mfma_f32_16x16x32_bf16 v[208:211], a[156:159], a[76:79], v[208:211]
    buffer_load_dwordx4 v23, s[16:19], s66 offen offset:3072 lds
    v_mfma_f32_16x16x32_bf16 v[212:215], a[160:163], a[64:67], v[200:203]
    v_exp_f32 v223, v223
    v_mfma_f32_16x16x32_bf16 v[212:215], a[164:167], a[68:71], v[212:215]
    v_cvt_pk_bf16_f32 v230, v220, v221
    v_cvt_pk_bf16_f32 v231, v222, v223
    v_mfma_f32_16x16x32_bf16 v[212:215], a[168:171], a[72:75], v[212:215]
    v_mfma_f32_16x16x32_bf16 v[212:215], a[172:175], a[76:79], v[212:215]
    s_add_u32 m0, s33, 0x5000
    v_exp_f32 v208, v208
    v_smfmac_f32_16x16x64_bf16 v[244:247], a[240:243], v[224:231], v6
    v_mfma_f32_16x16x32_bf16 a[120:123], a[184:187], v[228:231], a[120:123]
    s_bfe_u32 s68, s42, 0x40010
    v_exp_f32 v209, v209
    v_mfma_f32_16x16x32_bf16 v[136:139], v[228:231], a[188:191], v[136:139]
    buffer_load_dwordx4 v20, s[16:19], s67 offen lds
    v_mfma_f32_16x16x32_bf16 v[140:143], v[228:231], a[192:195], v[140:143]
    s_mul_i32 s68, s68, 0x2000
    v_exp_f32 v210, v210
    v_mfma_f32_16x16x32_bf16 v[144:147], v[228:231], a[196:199], v[144:147]
    buffer_load_dwordx4 v21, s[16:19], s67 offen offset:1024 lds
    v_mfma_f32_16x16x32_bf16 v[148:151], v[228:231], a[200:203], v[148:151]
    s_add_u32 s68, s68, s44
    v_exp_f32 v211, v211
    v_mfma_f32_16x16x32_bf16 a[124:127], a[204:207], v[228:231], a[124:127]
    s_and_b32 s68, s68, 0x1ffff
    v_cvt_pk_bf16_f32 v224, v208, v209
    v_cvt_pk_bf16_f32 v225, v210, v211
    v_mfma_f32_16x16x32_bf16 v[64:67], a[176:179], v[228:231], v[64:67]
    s_waitcnt vmcnt(14)
    v_exp_f32 v212, v212
    v_mfma_f32_16x16x32_bf16 v[68:71], a[180:183], v[228:231], v[68:71]
    buffer_load_dwordx4 v22, s[16:19], s67 offen offset:2048 lds
    v_mfma_f32_16x16x32_bf16 v[216:219], a[144:147], a[80:83], v[204:207]
    s_add_u32 s69, s68, 0x1000
    v_exp_f32 v213, v213
    v_mfma_f32_16x16x32_bf16 v[216:219], a[148:151], a[84:87], v[216:219]
    ds_read_b128 a[144:147], v8
    ds_read_b128 a[148:151], v9
    v_mfma_f32_16x16x32_bf16 v[216:219], a[152:155], a[88:91], v[216:219]
    v_exp_f32 v214, v214
    v_mfma_f32_16x16x32_bf16 v[216:219], a[156:159], a[92:95], v[216:219]
    ds_read_b128 a[152:155], v10
    ds_read_b128 a[156:159], v11
    v_mfma_f32_16x16x32_bf16 v[220:223], a[160:163], a[80:83], v[204:207]
    v_exp_f32 v215, v215
    v_mfma_f32_16x16x32_bf16 v[220:223], a[164:167], a[84:87], v[220:223]
    v_cvt_pk_bf16_f32 v226, v212, v213
    v_cvt_pk_bf16_f32 v227, v214, v215
    v_mfma_f32_16x16x32_bf16 v[220:223], a[168:171], a[88:91], v[220:223]
    ds_read_b128 a[160:163], v8 offset:4096
    ds_read_b128 a[164:167], v9 offset:4096
    v_mfma_f32_16x16x32_bf16 v[220:223], a[172:175], a[92:95], v[220:223]
    v_exp_f32 v216, v216
    v_mfma_f32_16x16x32_bf16 a[128:131], a[184:187], v[224:227], a[128:131]
    v_exp_f32 v217, v217
    v_mfma_f32_16x16x32_bf16 v[152:155], v[224:227], a[188:191], v[152:155]
    ds_read_b128 a[168:171], v10 offset:4096
    ds_read_b128 a[172:175], v11 offset:4096
    v_mfma_f32_16x16x32_bf16 v[156:159], v[224:227], a[192:195], v[156:159]
    v_exp_f32 v218, v218
    v_mfma_f32_16x16x32_bf16 v[160:163], v[224:227], a[196:199], v[160:163]
    buffer_load_dwordx4 v23, s[16:19], s67 offen offset:3072 lds
    v_mfma_f32_16x16x32_bf16 v[164:167], v[224:227], a[200:203], v[164:167]
    s_add_u32 m0, s33, 0x6000
    v_exp_f32 v219, v219
    v_mfma_f32_16x16x32_bf16 v[240:243], v[224:227], a[204:207], v[240:243]
    v_cvt_pk_bf16_f32 v228, v216, v217
    v_cvt_pk_bf16_f32 v229, v218, v219
    v_mfma_f32_16x16x32_bf16 v[72:75], a[176:179], v[224:227], v[72:75]
    v_exp_f32 v220, v220
    v_mfma_f32_16x16x32_bf16 v[76:79], a[180:183], v[224:227], v[76:79]
    s_waitcnt lgkmcnt(0)
    buffer_load_dwordx4 v24, s[20:23], s66 offen lds
    v_mfma_f32_16x16x32_bf16 v[208:211], a[144:147], a[0:3], v[184:187]
    v_exp_f32 v221, v221
    v_mfma_f32_16x16x32_bf16 v[208:211], a[148:151], a[4:7], v[208:211]
    buffer_load_dwordx4 v25, s[20:23], s66 offen offset:1024 lds
    v_mfma_f32_16x16x32_bf16 v[208:211], a[152:155], a[8:11], v[208:211]
    v_exp_f32 v222, v222
    v_mfma_f32_16x16x32_bf16 v[208:211], a[156:159], a[12:15], v[208:211]
    buffer_load_dwordx4 v24, s[20:23], s66 offen offset:2048 lds
    v_mfma_f32_16x16x32_bf16 v[212:215], a[160:163], a[0:3], v[184:187]
    v_exp_f32 v223, v223
    v_mfma_f32_16x16x32_bf16 v[212:215], a[164:167], a[4:7], v[212:215]
    v_cvt_pk_bf16_f32 v230, v220, v221
    v_cvt_pk_bf16_f32 v231, v222, v223
    v_mfma_f32_16x16x32_bf16 v[212:215], a[168:171], a[8:11], v[212:215]
    s_waitcnt vmcnt(11)
    buffer_load_dwordx4 v25, s[20:23], s66 offen offset:3072 lds
    v_mfma_f32_16x16x32_bf16 v[212:215], a[172:175], a[12:15], v[212:215]
    s_add_u32 m0, s33, 0x7000
    v_exp_f32 v208, v208
    v_smfmac_f32_16x16x64_bf16 v[252:255], a[240:243], v[224:231], v6
    buffer_load_dwordx4 v24, s[20:23], s67 offen lds
    v_mfma_f32_16x16x32_bf16 v[232:235], v[228:231], a[184:187], v[232:235]
    v_exp_f32 v209, v209
    v_mfma_f32_16x16x32_bf16 v[168:171], v[228:231], a[188:191], v[168:171]
    ds_read_b64_tr_b16 a[184:185], v14 offset:8192
    ds_read_b64_tr_b16 a[186:187], v14 offset:12288
    v_mfma_f32_16x16x32_bf16 v[172:175], v[228:231], a[192:195], v[172:175]
    v_exp_f32 v210, v210
    v_mfma_f32_16x16x32_bf16 v[176:179], v[228:231], a[196:199], v[176:179]
    ds_read_b64_tr_b16 a[188:189], v15 offset:8192
    ds_read_b64_tr_b16 a[190:191], v15 offset:12288
    buffer_load_dwordx4 v25, s[20:23], s67 offen offset:1024 lds
    v_mfma_f32_16x16x32_bf16 v[180:183], v[228:231], a[200:203], v[180:183]
    v_exp_f32 v211, v211
    v_mfma_f32_16x16x32_bf16 v[248:251], v[228:231], a[204:207], v[248:251]
    v_cvt_pk_bf16_f32 v224, v208, v209
    v_cvt_pk_bf16_f32 v225, v210, v211
    v_mfma_f32_16x16x32_bf16 v[80:83], a[176:179], v[228:231], v[80:83]
    v_exp_f32 v212, v212
    v_mfma_f32_16x16x32_bf16 v[84:87], a[180:183], v[228:231], v[84:87]
    ds_read_b64_tr_b16 a[192:193], v16 offset:8192
    ds_read_b64_tr_b16 a[194:195], v16 offset:12288
    v_mfma_f32_16x16x32_bf16 v[216:219], a[144:147], a[16:19], v[188:191]
    v_exp_f32 v213, v213
    v_mfma_f32_16x16x32_bf16 v[216:219], a[148:151], a[20:23], v[216:219]
    ds_read_b64_tr_b16 a[196:197], v17 offset:8192
    ds_read_b64_tr_b16 a[198:199], v17 offset:12288
    v_mfma_f32_16x16x32_bf16 v[216:219], a[152:155], a[24:27], v[216:219]
    v_exp_f32 v214, v214
    v_mfma_f32_16x16x32_bf16 v[216:219], a[156:159], a[28:31], v[216:219]
    ds_read_b64_tr_b16 a[200:201], v18 offset:8192
    ds_read_b64_tr_b16 a[202:203], v18 offset:12288
    v_mfma_f32_16x16x32_bf16 v[220:223], a[160:163], a[16:19], v[188:191]
    v_exp_f32 v215, v215
    v_mfma_f32_16x16x32_bf16 v[220:223], a[164:167], a[20:23], v[220:223]
    v_cvt_pk_bf16_f32 v226, v212, v213
    v_cvt_pk_bf16_f32 v227, v214, v215
    v_mfma_f32_16x16x32_bf16 v[220:223], a[168:171], a[24:27], v[220:223]
    ds_read_b64_tr_b16 a[204:205], v19 offset:8192
    ds_read_b64_tr_b16 a[206:207], v19 offset:12288
    ds_read_b64_tr_b16 a[176:177], v12 offset:8192
    v_mfma_f32_16x16x32_bf16 v[220:223], a[172:175], a[28:31], v[220:223]
    ds_read_b64_tr_b16 a[178:179], v12 offset:12288
    v_exp_f32 v216, v216
    s_waitcnt lgkmcnt(6)
    v_mfma_f32_16x16x32_bf16 a[96:99], a[184:187], v[224:227], a[96:99]
    v_exp_f32 v217, v217
    v_mfma_f32_16x16x32_bf16 v[88:91], v[224:227], a[188:191], v[88:91]
    ds_read_b64_tr_b16 a[180:181], v13 offset:8192
    ds_read_b64_tr_b16 a[182:183], v13 offset:12288
    v_mfma_f32_16x16x32_bf16 v[92:95], v[224:227], a[192:195], v[92:95]
    v_exp_f32 v218, v218
    v_mfma_f32_16x16x32_bf16 v[96:99], v[224:227], a[196:199], v[96:99]
    s_waitcnt lgkmcnt(0)
    buffer_load_dwordx4 v24, s[20:23], s67 offen offset:2048 lds
    v_mfma_f32_16x16x32_bf16 v[100:103], v[224:227], a[200:203], v[100:103]
    v_exp_f32 v219, v219
    v_mfma_f32_16x16x32_bf16 a[100:103], a[204:207], v[224:227], a[100:103]
    v_cvt_pk_bf16_f32 v228, v216, v217
    v_cvt_pk_bf16_f32 v229, v218, v219
    v_mfma_f32_16x16x32_bf16 v[40:43], a[176:179], v[224:227], v[40:43]
    v_exp_f32 v220, v220
    v_mfma_f32_16x16x32_bf16 v[44:47], a[180:183], v[224:227], v[44:47]
    buffer_load_dwordx4 v25, s[20:23], s67 offen offset:3072 lds
    v_mfma_f32_16x16x32_bf16 v[208:211], a[144:147], a[32:35], v[192:195]
    s_mov_b32 m0, s33
    v_exp_f32 v221, v221
    v_mfma_f32_16x16x32_bf16 v[208:211], a[148:151], a[36:39], v[208:211]
    buffer_load_dwordx4 v20, s[16:19], s68 offen lds
    v_mfma_f32_16x16x32_bf16 v[208:211], a[152:155], a[40:43], v[208:211]
    v_exp_f32 v222, v222
    v_mfma_f32_16x16x32_bf16 v[208:211], a[156:159], a[44:47], v[208:211]
    buffer_load_dwordx4 v21, s[16:19], s68 offen offset:1024 lds
    v_mfma_f32_16x16x32_bf16 v[212:215], a[160:163], a[32:35], v[192:195]
L_t5:
    s_cbranch_vccnz L_tr
    v_exp_f32 v223, v223
    v_mfma_f32_16x16x32_bf16 v[212:215], a[164:167], a[36:39], v[212:215]
    v_cvt_pk_bf16_f32 v230, v220, v221
    v_cvt_pk_bf16_f32 v231, v222, v223
    v_mfma_f32_16x16x32_bf16 v[212:215], a[168:171], a[40:43], v[212:215]
    buffer_load_dwordx4 v22, s[16:19], s68 offen offset:2048 lds
    v_mfma_f32_16x16x32_bf16 v[212:215], a[172:175], a[44:47], v[212:215]
    v_exp_f32 v208, v208
    v_smfmac_f32_16x16x64_bf16 v[236:239], a[240:243], v[224:231], v6
    v_mfma_f32_16x16x32_bf16 a[104:107], a[184:187], v[228:231], a[104:107]
    v_exp_f32 v209, v209
    v_mfma_f32_16x16x32_bf16 v[104:107], v[228:231], a[188:191], v[104:107]
    buffer_load_dwordx4 v23, s[16:19], s68 offen offset:3072 lds
    v_mfma_f32_16x16x32_bf16 v[108:111], v[228:231], a[192:195], v[108:111]
    s_add_u32 m0, s33, 0x1000
    v_exp_f32 v210, v210
    v_mfma_f32_16x16x32_bf16 v[112:115], v[228:231], a[196:199], v[112:115]
    buffer_load_dwordx4 v20, s[16:19], s69 offen lds
    v_mfma_f32_16x16x32_bf16 v[116:119], v[228:231], a[200:203], v[116:119]
    v_exp_f32 v211, v211
    v_mfma_f32_16x16x32_bf16 a[108:111], a[204:207], v[228:231], a[108:111]
    v_cvt_pk_bf16_f32 v224, v208, v209
    v_cvt_pk_bf16_f32 v225, v210, v211
    v_mfma_f32_16x16x32_bf16 v[48:51], a[176:179], v[228:231], v[48:51]
    v_exp_f32 v212, v212
    v_mfma_f32_16x16x32_bf16 v[52:55], a[180:183], v[228:231], v[52:55]
    buffer_load_dwordx4 v21, s[16:19], s69 offen offset:1024 lds
    v_mfma_f32_16x16x32_bf16 v[216:219], a[144:147], a[48:51], v[196:199]
    v_exp_f32 v213, v213
    v_mfma_f32_16x16x32_bf16 v[216:219], a[148:151], a[52:55], v[216:219]
    buffer_load_dwordx4 v22, s[16:19], s69 offen offset:2048 lds
    v_mfma_f32_16x16x32_bf16 v[216:219], a[152:155], a[56:59], v[216:219]
    v_exp_f32 v214, v214
    v_mfma_f32_16x16x32_bf16 v[216:219], a[156:159], a[60:63], v[216:219]
    v_mfma_f32_16x16x32_bf16 v[220:223], a[160:163], a[48:51], v[196:199]
    v_exp_f32 v215, v215
    v_mfma_f32_16x16x32_bf16 v[220:223], a[164:167], a[52:55], v[220:223]
    v_cvt_pk_bf16_f32 v226, v212, v213
    v_cvt_pk_bf16_f32 v227, v214, v215
    v_mfma_f32_16x16x32_bf16 v[220:223], a[168:171], a[56:59], v[220:223]
    buffer_load_dwordx4 v23, s[16:19], s69 offen offset:3072 lds
    v_mfma_f32_16x16x32_bf16 v[220:223], a[172:175], a[60:63], v[220:223]
    v_exp_f32 v216, v216
    v_mfma_f32_16x16x32_bf16 a[112:115], a[184:187], v[224:227], a[112:115]
    v_exp_f32 v217, v217
    v_mfma_f32_16x16x32_bf16 v[120:123], v[224:227], a[188:191], v[120:123]
    v_mfma_f32_16x16x32_bf16 v[124:127], v[224:227], a[192:195], v[124:127]
    v_exp_f32 v218, v218
    v_mfma_f32_16x16x32_bf16 v[128:131], v[224:227], a[196:199], v[128:131]
    v_mfma_f32_16x16x32_bf16 v[132:135], v[224:227], a[200:203], v[132:135]
    v_exp_f32 v219, v219
    v_mfma_f32_16x16x32_bf16 a[116:119], a[204:207], v[224:227], a[116:119]
    v_cvt_pk_bf16_f32 v228, v216, v217
    v_cvt_pk_bf16_f32 v229, v218, v219
    v_mfma_f32_16x16x32_bf16 v[56:59], a[176:179], v[224:227], v[56:59]
    v_exp_f32 v220, v220
    v_mfma_f32_16x16x32_bf16 v[60:63], a[180:183], v[224:227], v[60:63]
    v_mfma_f32_16x16x32_bf16 v[208:211], a[144:147], a[64:67], v[200:203]
    v_exp_f32 v221, v221
    v_mfma_f32_16x16x32_bf16 v[208:211], a[148:151], a[68:71], v[208:211]
    v_mfma_f32_16x16x32_bf16 v[208:211], a[152:155], a[72:75], v[208:211]
    v_exp_f32 v222, v222
    v_mfma_f32_16x16x32_bf16 v[208:211], a[156:159], a[76:79], v[208:211]
    v_mfma_f32_16x16x32_bf16 v[212:215], a[160:163], a[64:67], v[200:203]
    v_exp_f32 v223, v223
    v_mfma_f32_16x16x32_bf16 v[212:215], a[164:167], a[68:71], v[212:215]
    v_cvt_pk_bf16_f32 v230, v220, v221
    v_cvt_pk_bf16_f32 v231, v222, v223
    v_mfma_f32_16x16x32_bf16 v[212:215], a[168:171], a[72:75], v[212:215]
    v_mfma_f32_16x16x32_bf16 v[212:215], a[172:175], a[76:79], v[212:215]
    v_exp_f32 v208, v208
    v_smfmac_f32_16x16x64_bf16 v[244:247], a[240:243], v[224:231], v6
    v_mfma_f32_16x16x32_bf16 a[120:123], a[184:187], v[228:231], a[120:123]
    v_exp_f32 v209, v209
    v_mfma_f32_16x16x32_bf16 v[136:139], v[228:231], a[188:191], v[136:139]
    v_mfma_f32_16x16x32_bf16 v[140:143], v[228:231], a[192:195], v[140:143]
    v_exp_f32 v210, v210
    v_mfma_f32_16x16x32_bf16 v[144:147], v[228:231], a[196:199], v[144:147]
    v_mfma_f32_16x16x32_bf16 v[148:151], v[228:231], a[200:203], v[148:151]
    v_exp_f32 v211, v211
    v_mfma_f32_16x16x32_bf16 a[124:127], a[204:207], v[228:231], a[124:127]
    v_cvt_pk_bf16_f32 v224, v208, v209
    v_cvt_pk_bf16_f32 v225, v210, v211
    v_mfma_f32_16x16x32_bf16 v[64:67], a[176:179], v[228:231], v[64:67]
    s_waitcnt vmcnt(16)
    v_exp_f32 v212, v212
    v_mfma_f32_16x16x32_bf16 v[68:71], a[180:183], v[228:231], v[68:71]
    v_mfma_f32_16x16x32_bf16 v[216:219], a[144:147], a[80:83], v[204:207]
    v_exp_f32 v213, v213
    v_mfma_f32_16x16x32_bf16 v[216:219], a[148:151], a[84:87], v[216:219]
    ds_read_b128 a[144:147], v8 offset:16384
    ds_read_b128 a[148:151], v9 offset:16384
    v_mfma_f32_16x16x32_bf16 v[216:219], a[152:155], a[88:91], v[216:219]
    v_exp_f32 v214, v214
    v_mfma_f32_16x16x32_bf16 v[216:219], a[156:159], a[92:95], v[216:219]
    ds_read_b128 a[152:155], v10 offset:16384
    ds_read_b128 a[156:159], v11 offset:16384
    v_mfma_f32_16x16x32_bf16 v[220:223], a[160:163], a[80:83], v[204:207]
    v_exp_f32 v215, v215
    v_mfma_f32_16x16x32_bf16 v[220:223], a[164:167], a[84:87], v[220:223]
    v_cvt_pk_bf16_f32 v226, v212, v213
    v_cvt_pk_bf16_f32 v227, v214, v215
    v_mfma_f32_16x16x32_bf16 v[220:223], a[168:171], a[88:91], v[220:223]
    ds_read_b128 a[160:163], v8 offset:20480
    ds_read_b128 a[164:167], v9 offset:20480
    v_mfma_f32_16x16x32_bf16 v[220:223], a[172:175], a[92:95], v[220:223]
    v_exp_f32 v216, v216
    v_mfma_f32_16x16x32_bf16 a[128:131], a[184:187], v[224:227], a[128:131]
    s_add_u32 m0, s33, 0x2000
    v_exp_f32 v217, v217
    v_mfma_f32_16x16x32_bf16 v[152:155], v[224:227], a[188:191], v[152:155]
    ds_read_b128 a[168:171], v10 offset:20480
    ds_read_b128 a[172:175], v11 offset:20480
    v_mfma_f32_16x16x32_bf16 v[156:159], v[224:227], a[192:195], v[156:159]
    v_exp_f32 v218, v218
    v_mfma_f32_16x16x32_bf16 v[160:163], v[224:227], a[196:199], v[160:163]
    buffer_load_dwordx4 v24, s[20:23], s68 offen lds
    v_mfma_f32_16x16x32_bf16 v[164:167], v[224:227], a[200:203], v[164:167]
    v_exp_f32 v219, v219
    v_mfma_f32_16x16x32_bf16 v[240:243], v[224:227], a[204:207], v[240:243]
    v_cvt_pk_bf16_f32 v228, v216, v217
    v_cvt_pk_bf16_f32 v229, v218, v219
    v_mfma_f32_16x16x32_bf16 v[72:75], a[176:179], v[224:227], v[72:75]
    v_exp_f32 v220, v220
    v_mfma_f32_16x16x32_bf16 v[76:79], a[180:183], v[224:227], v[76:79]
    s_waitcnt lgkmcnt(0)
    buffer_load_dwordx4 v25, s[20:23], s68 offen offset:1024 lds
    v_mfma_f32_16x16x32_bf16 v[208:211], a[144:147], a[0:3], v[184:187]
    v_exp_f32 v221, v221
    v_mfma_f32_16x16x32_bf16 v[208:211], a[148:151], a[4:7], v[208:211]
    buffer_load_dwordx4 v24, s[20:23], s68 offen offset:2048 lds
    v_mfma_f32_16x16x32_bf16 v[208:211], a[152:155], a[8:11], v[208:211]
    s_bfe_u32 s70, s42, 0x40014
    v_exp_f32 v222, v222
    v_mfma_f32_16x16x32_bf16 v[208:211], a[156:159], a[12:15], v[208:211]
    buffer_load_dwordx4 v25, s[20:23], s68 offen offset:3072 lds
    v_mfma_f32_16x16x32_bf16 v[212:215], a[160:163], a[0:3], v[184:187]
    s_mul_i32 s70, s70, 0x2000
    v_exp_f32 v223, v223
    v_mfma_f32_16x16x32_bf16 v[212:215], a[164:167], a[4:7], v[212:215]
    s_add_u32 s70, s70, s44
    v_cvt_pk_bf16_f32 v230, v220, v221
    v_cvt_pk_bf16_f32 v231, v222, v223
    v_mfma_f32_16x16x32_bf16 v[212:215], a[168:171], a[8:11], v[212:215]
    s_waitcnt vmcnt(12)
    v_mfma_f32_16x16x32_bf16 v[212:215], a[172:175], a[12:15], v[212:215]
    s_add_u32 m0, s33, 0x3000
    v_exp_f32 v208, v208
    v_smfmac_f32_16x16x64_bf16 v[252:255], a[240:243], v[224:231], v6
    buffer_load_dwordx4 v24, s[20:23], s69 offen lds
    v_mfma_f32_16x16x32_bf16 v[232:235], v[228:231], a[184:187], v[232:235]
    s_and_b32 s70, s70, 0x1ffff
    v_exp_f32 v209, v209
    v_mfma_f32_16x16x32_bf16 v[168:171], v[228:231], a[188:191], v[168:171]
    s_add_u32 s71, s70, 0x1000
    ds_read_b64_tr_b16 a[184:185], v14 offset:24576
    ds_read_b64_tr_b16 a[186:187], v14 offset:28672
    v_mfma_f32_16x16x32_bf16 v[172:175], v[228:231], a[192:195], v[172:175]
    v_exp_f32 v210, v210
    v_mfma_f32_16x16x32_bf16 v[176:179], v[228:231], a[196:199], v[176:179]
    ds_read_b64_tr_b16 a[188:189], v15 offset:24576
    ds_read_b64_tr_b16 a[190:191], v15 offset:28672
    buffer_load_dwordx4 v25, s[20:23], s69 offen offset:1024 lds
    v_mfma_f32_16x16x32_bf16 v[180:183], v[228:231], a[200:203], v[180:183]
    v_exp_f32 v211, v211
    v_mfma_f32_16x16x32_bf16 v[248:251], v[228:231], a[204:207], v[248:251]
    v_cvt_pk_bf16_f32 v224, v208, v209
    v_cvt_pk_bf16_f32 v225, v210, v211
    v_mfma_f32_16x16x32_bf16 v[80:83], a[176:179], v[228:231], v[80:83]
    v_exp_f32 v212, v212
    v_mfma_f32_16x16x32_bf16 v[84:87], a[180:183], v[228:231], v[84:87]
    ds_read_b64_tr_b16 a[192:193], v16 offset:24576
    ds_read_b64_tr_b16 a[194:195], v16 offset:28672
    v_mfma_f32_16x16x32_bf16 v[216:219], a[144:147], a[16:19], v[188:191]
    v_exp_f32 v213, v213
    v_mfma_f32_16x16x32_bf16 v[216:219], a[148:151], a[20:23], v[216:219]
    ds_read_b64_tr_b16 a[196:197], v17 offset:24576
    ds_read_b64_tr_b16 a[198:199], v17 offset:28672
    v_mfma_f32_16x16x32_bf16 v[216:219], a[152:155], a[24:27], v[216:219]
    v_exp_f32 v214, v214
    v_mfma_f32_16x16x32_bf16 v[216:219], a[156:159], a[28:31], v[216:219]
    ds_read_b64_tr_b16 a[200:201], v18 offset:24576
    ds_read_b64_tr_b16 a[202:203], v18 offset:28672
    v_mfma_f32_16x16x32_bf16 v[220:223], a[160:163], a[16:19], v[188:191]
    v_exp_f32 v215, v215
    v_mfma_f32_16x16x32_bf16 v[220:223], a[164:167], a[20:23], v[220:223]
    v_cvt_pk_bf16_f32 v226, v212, v213
    v_cvt_pk_bf16_f32 v227, v214, v215
    v_mfma_f32_16x16x32_bf16 v[220:223], a[168:171], a[24:27], v[220:223]
    ds_read_b64_tr_b16 a[204:205], v19 offset:24576
    ds_read_b64_tr_b16 a[206:207], v19 offset:28672
    ds_read_b64_tr_b16 a[176:177], v12 offset:24576
    v_mfma_f32_16x16x32_bf16 v[220:223], a[172:175], a[28:31], v[220:223]
    ds_read_b64_tr_b16 a[178:179], v12 offset:28672
    v_exp_f32 v216, v216
    s_waitcnt lgkmcnt(6)
    v_mfma_f32_16x16x32_bf16 a[96:99], a[184:187], v[224:227], a[96:99]
    v_exp_f32 v217, v217
    v_mfma_f32_16x16x32_bf16 v[88:91], v[224:227], a[188:191], v[88:91]
    ds_read_b64_tr_b16 a[180:181], v13 offset:24576
    ds_read_b64_tr_b16 a[182:183], v13 offset:28672
    v_mfma_f32_16x16x32_bf16 v[92:95], v[224:227], a[192:195], v[92:95]
    v_exp_f32 v218, v218
    v_mfma_f32_16x16x32_bf16 v[96:99], v[224:227], a[196:199], v[96:99]
    s_waitcnt lgkmcnt(0)
    buffer_load_dwordx4 v24, s[20:23], s69 offen offset:2048 lds
    v_mfma_f32_16x16x32_bf16 v[100:103], v[224:227], a[200:203], v[100:103]
    v_exp_f32 v219, v219
    v_mfma_f32_16x16x32_bf16 a[100:103], a[204:207], v[224:227], a[100:103]
    v_cvt_pk_bf16_f32 v228, v216, v217
    v_cvt_pk_bf16_f32 v229, v218, v219
    v_mfma_f32_16x16x32_bf16 v[40:43], a[176:179], v[224:227], v[40:43]
    v_exp_f32 v220, v220
    v_mfma_f32_16x16x32_bf16 v[44:47], a[180:183], v[224:227], v[44:47]
    buffer_load_dwordx4 v25, s[20:23], s69 offen offset:3072 lds
    v_mfma_f32_16x16x32_bf16 v[208:211], a[144:147], a[32:35], v[192:195]
    v_exp_f32 v221, v221
    v_mfma_f32_16x16x32_bf16 v[208:211], a[148:151], a[36:39], v[208:211]
    v_mfma_f32_16x16x32_bf16 v[208:211], a[152:155], a[40:43], v[208:211]
    v_exp_f32 v222, v222
    v_mfma_f32_16x16x32_bf16 v[208:211], a[156:159], a[44:47], v[208:211]
    v_mfma_f32_16x16x32_bf16 v[212:215], a[160:163], a[32:35], v[192:195]
    v_exp_f32 v223, v223
    v_mfma_f32_16x16x32_bf16 v[212:215], a[164:167], a[36:39], v[212:215]
    v_cvt_pk_bf16_f32 v230, v220, v221
    v_cvt_pk_bf16_f32 v231, v222, v223
    v_mfma_f32_16x16x32_bf16 v[212:215], a[168:171], a[40:43], v[212:215]
    v_mfma_f32_16x16x32_bf16 v[212:215], a[172:175], a[44:47], v[212:215]
    v_exp_f32 v208, v208
    v_smfmac_f32_16x16x64_bf16 v[236:239], a[240:243], v[224:231], v6
    v_mfma_f32_16x16x32_bf16 a[104:107], a[184:187], v[228:231], a[104:107]
    v_exp_f32 v209, v209
    v_mfma_f32_16x16x32_bf16 v[104:107], v[228:231], a[188:191], v[104:107]
    v_mfma_f32_16x16x32_bf16 v[108:111], v[228:231], a[192:195], v[108:111]
    v_exp_f32 v210, v210
    v_mfma_f32_16x16x32_bf16 v[112:115], v[228:231], a[196:199], v[112:115]
    v_mfma_f32_16x16x32_bf16 v[116:119], v[228:231], a[200:203], v[116:119]
    v_exp_f32 v211, v211
    v_mfma_f32_16x16x32_bf16 a[108:111], a[204:207], v[228:231], a[108:111]
    v_cvt_pk_bf16_f32 v224, v208, v209
    v_cvt_pk_bf16_f32 v225, v210, v211
    v_mfma_f32_16x16x32_bf16 v[48:51], a[176:179], v[228:231], v[48:51]
    v_exp_f32 v212, v212
    v_mfma_f32_16x16x32_bf16 v[52:55], a[180:183], v[228:231], v[52:55]
    v_mfma_f32_16x16x32_bf16 v[216:219], a[144:147], a[48:51], v[196:199]
    v_exp_f32 v213, v213
    v_mfma_f32_16x16x32_bf16 v[216:219], a[148:151], a[52:55], v[216:219]
    v_mfma_f32_16x16x32_bf16 v[216:219], a[152:155], a[56:59], v[216:219]
    v_exp_f32 v214, v214
    v_mfma_f32_16x16x32_bf16 v[216:219], a[156:159], a[60:63], v[216:219]
    v_mfma_f32_16x16x32_bf16 v[220:223], a[160:163], a[48:51], v[196:199]
    v_exp_f32 v215, v215
    v_mfma_f32_16x16x32_bf16 v[220:223], a[164:167], a[52:55], v[220:223]
    v_cvt_pk_bf16_f32 v226, v212, v213
    v_cvt_pk_bf16_f32 v227, v214, v215
    v_mfma_f32_16x16x32_bf16 v[220:223], a[168:171], a[56:59], v[220:223]
    v_mfma_f32_16x16x32_bf16 v[220:223], a[172:175], a[60:63], v[220:223]
    v_exp_f32 v216, v216
    v_mfma_f32_16x16x32_bf16 a[112:115], a[184:187], v[224:227], a[112:115]
    s_add_u32 m0, s33, 0x4000
    v_exp_f32 v217, v217
    v_mfma_f32_16x16x32_bf16 v[120:123], v[224:227], a[188:191], v[120:123]
    buffer_load_dwordx4 v20, s[16:19], s70 offen lds
    v_mfma_f32_16x16x32_bf16 v[124:127], v[224:227], a[192:195], v[124:127]
    v_exp_f32 v218, v218
    v_mfma_f32_16x16x32_bf16 v[128:131], v[224:227], a[196:199], v[128:131]
    buffer_load_dwordx4 v21, s[16:19], s70 offen offset:1024 lds
    v_mfma_f32_16x16x32_bf16 v[132:135], v[224:227], a[200:203], v[132:135]
    v_exp_f32 v219, v219
    v_mfma_f32_16x16x32_bf16 a[116:119], a[204:207], v[224:227], a[116:119]
    v_cvt_pk_bf16_f32 v228, v216, v217
    v_cvt_pk_bf16_f32 v229, v218, v219
    v_mfma_f32_16x16x32_bf16 v[56:59], a[176:179], v[224:227], v[56:59]
    v_exp_f32 v220, v220
    v_mfma_f32_16x16x32_bf16 v[60:63], a[180:183], v[224:227], v[60:63]
    buffer_load_dwordx4 v22, s[16:19], s70 offen offset:2048 lds
    v_mfma_f32_16x16x32_bf16 v[208:211], a[144:147], a[64:67], v[200:203]
    v_exp_f32 v221, v221
    v_mfma_f32_16x16x32_bf16 v[208:211], a[148:151], a[68:71], v[208:211]
    v_mfma_f32_16x16x32_bf16 v[208:211], a[152:155], a[72:75], v[208:211]
    v_exp_f32 v222, v222
    v_mfma_f32_16x16x32_bf16 v[208:211], a[156:159], a[76:79], v[208:211]
    buffer_load_dwordx4 v23, s[16:19], s70 offen offset:3072 lds
    v_mfma_f32_16x16x32_bf16 v[212:215], a[160:163], a[64:67], v[200:203]
    v_exp_f32 v223, v223
    v_mfma_f32_16x16x32_bf16 v[212:215], a[164:167], a[68:71], v[212:215]
    v_cvt_pk_bf16_f32 v230, v220, v221
    v_cvt_pk_bf16_f32 v231, v222, v223
    v_mfma_f32_16x16x32_bf16 v[212:215], a[168:171], a[72:75], v[212:215]
    v_mfma_f32_16x16x32_bf16 v[212:215], a[172:175], a[76:79], v[212:215]
    s_add_u32 m0, s33, 0x5000
    v_exp_f32 v208, v208
    v_smfmac_f32_16x16x64_bf16 v[244:247], a[240:243], v[224:231], v6
    v_mfma_f32_16x16x32_bf16 a[120:123], a[184:187], v[228:231], a[120:123]
    s_bfe_u32 s72, s42, 0x40018
    v_exp_f32 v209, v209
    v_mfma_f32_16x16x32_bf16 v[136:139], v[228:231], a[188:191], v[136:139]
    buffer_load_dwordx4 v20, s[16:19], s71 offen lds
    v_mfma_f32_16x16x32_bf16 v[140:143], v[228:231], a[192:195], v[140:143]
    s_mul_i32 s72, s72, 0x2000
    v_exp_f32 v210, v210
    v_mfma_f32_16x16x32_bf16 v[144:147], v[228:231], a[196:199], v[144:147]
    buffer_load_dwordx4 v21, s[16:19], s71 offen offset:1024 lds
    v_mfma_f32_16x16x32_bf16 v[148:151], v[228:231], a[200:203], v[148:151]
    s_add_u32 s72, s72, s44
    v_exp_f32 v211, v211
    v_mfma_f32_16x16x32_bf16 a[124:127], a[204:207], v[228:231], a[124:127]
    s_and_b32 s72, s72, 0x1ffff
    v_cvt_pk_bf16_f32 v224, v208, v209
    v_cvt_pk_bf16_f32 v225, v210, v211
    v_mfma_f32_16x16x32_bf16 v[64:67], a[176:179], v[228:231], v[64:67]
    s_waitcnt vmcnt(14)
    v_exp_f32 v212, v212
    v_mfma_f32_16x16x32_bf16 v[68:71], a[180:183], v[228:231], v[68:71]
    buffer_load_dwordx4 v22, s[16:19], s71 offen offset:2048 lds
    v_mfma_f32_16x16x32_bf16 v[216:219], a[144:147], a[80:83], v[204:207]
    s_add_u32 s73, s72, 0x1000
    v_exp_f32 v213, v213
    v_mfma_f32_16x16x32_bf16 v[216:219], a[148:151], a[84:87], v[216:219]
    ds_read_b128 a[144:147], v8
    ds_read_b128 a[148:151], v9
    v_mfma_f32_16x16x32_bf16 v[216:219], a[152:155], a[88:91], v[216:219]
    v_exp_f32 v214, v214
    v_mfma_f32_16x16x32_bf16 v[216:219], a[156:159], a[92:95], v[216:219]
    ds_read_b128 a[152:155], v10
    ds_read_b128 a[156:159], v11
    v_mfma_f32_16x16x32_bf16 v[220:223], a[160:163], a[80:83], v[204:207]
    v_exp_f32 v215, v215
    v_mfma_f32_16x16x32_bf16 v[220:223], a[164:167], a[84:87], v[220:223]
    v_cvt_pk_bf16_f32 v226, v212, v213
    v_cvt_pk_bf16_f32 v227, v214, v215
    v_mfma_f32_16x16x32_bf16 v[220:223], a[168:171], a[88:91], v[220:223]
    ds_read_b128 a[160:163], v8 offset:4096
    ds_read_b128 a[164:167], v9 offset:4096
    v_mfma_f32_16x16x32_bf16 v[220:223], a[172:175], a[92:95], v[220:223]
    v_exp_f32 v216, v216
    v_mfma_f32_16x16x32_bf16 a[128:131], a[184:187], v[224:227], a[128:131]
    v_exp_f32 v217, v217
    v_mfma_f32_16x16x32_bf16 v[152:155], v[224:227], a[188:191], v[152:155]
    ds_read_b128 a[168:171], v10 offset:4096
    ds_read_b128 a[172:175], v11 offset:4096
    v_mfma_f32_16x16x32_bf16 v[156:159], v[224:227], a[192:195], v[156:159]
    v_exp_f32 v218, v218
    v_mfma_f32_16x16x32_bf16 v[160:163], v[224:227], a[196:199], v[160:163]
    buffer_load_dwordx4 v23, s[16:19], s71 offen offset:3072 lds
    v_mfma_f32_16x16x32_bf16 v[164:167], v[224:227], a[200:203], v[164:167]
    s_add_u32 m0, s33, 0x6000
    v_exp_f32 v219, v219
    v_mfma_f32_16x16x32_bf16 v[240:243], v[224:227], a[204:207], v[240:243]
    v_cvt_pk_bf16_f32 v228, v216, v217
    v_cvt_pk_bf16_f32 v229, v218, v219
    v_mfma_f32_16x16x32_bf16 v[72:75], a[176:179], v[224:227], v[72:75]
    v_exp_f32 v220, v220
    v_mfma_f32_16x16x32_bf16 v[76:79], a[180:183], v[224:227], v[76:79]
    s_waitcnt lgkmcnt(0)
    buffer_load_dwordx4 v24, s[20:23], s70 offen lds
    v_mfma_f32_16x16x32_bf16 v[208:211], a[144:147], a[0:3], v[184:187]
    v_exp_f32 v221, v221
    v_mfma_f32_16x16x32_bf16 v[208:211], a[148:151], a[4:7], v[208:211]
    buffer_load_dwordx4 v25, s[20:23], s70 offen offset:1024 lds
    v_mfma_f32_16x16x32_bf16 v[208:211], a[152:155], a[8:11], v[208:211]
    v_exp_f32 v222, v222
    v_mfma_f32_16x16x32_bf16 v[208:211], a[156:159], a[12:15], v[208:211]
    buffer_load_dwordx4 v24, s[20:23], s70 offen offset:2048 lds
    v_mfma_f32_16x16x32_bf16 v[212:215], a[160:163], a[0:3], v[184:187]
    v_exp_f32 v223, v223
    v_mfma_f32_16x16x32_bf16 v[212:215], a[164:167], a[4:7], v[212:215]
    v_cvt_pk_bf16_f32 v230, v220, v221
    v_cvt_pk_bf16_f32 v231, v222, v223
    v_mfma_f32_16x16x32_bf16 v[212:215], a[168:171], a[8:11], v[212:215]
    s_waitcnt vmcnt(11)
    buffer_load_dwordx4 v25, s[20:23], s70 offen offset:3072 lds
    v_mfma_f32_16x16x32_bf16 v[212:215], a[172:175], a[12:15], v[212:215]
    s_add_u32 m0, s33, 0x7000
    v_exp_f32 v208, v208
    v_smfmac_f32_16x16x64_bf16 v[252:255], a[240:243], v[224:231], v6
    buffer_load_dwordx4 v24, s[20:23], s71 offen lds
    v_mfma_f32_16x16x32_bf16 v[232:235], v[228:231], a[184:187], v[232:235]
    v_exp_f32 v209, v209
    v_mfma_f32_16x16x32_bf16 v[168:171], v[228:231], a[188:191], v[168:171]
    ds_read_b64_tr_b16 a[184:185], v14 offset:8192
    ds_read_b64_tr_b16 a[186:187], v14 offset:12288
    v_mfma_f32_16x16x32_bf16 v[172:175], v[228:231], a[192:195], v[172:175]
    v_exp_f32 v210, v210
    v_mfma_f32_16x16x32_bf16 v[176:179], v[228:231], a[196:199], v[176:179]
    ds_read_b64_tr_b16 a[188:189], v15 offset:8192
    ds_read_b64_tr_b16 a[190:191], v15 offset:12288
    buffer_load_dwordx4 v25, s[20:23], s71 offen offset:1024 lds
    v_mfma_f32_16x16x32_bf16 v[180:183], v[228:231], a[200:203], v[180:183]
    v_exp_f32 v211, v211
    v_mfma_f32_16x16x32_bf16 v[248:251], v[228:231], a[204:207], v[248:251]
    v_cvt_pk_bf16_f32 v224, v208, v209
    v_cvt_pk_bf16_f32 v225, v210, v211
    v_mfma_f32_16x16x32_bf16 v[80:83], a[176:179], v[228:231], v[80:83]
    v_exp_f32 v212, v212
    v_mfma_f32_16x16x32_bf16 v[84:87], a[180:183], v[228:231], v[84:87]
    ds_read_b64_tr_b16 a[192:193], v16 offset:8192
    ds_read_b64_tr_b16 a[194:195], v16 offset:12288
    v_mfma_f32_16x16x32_bf16 v[216:219], a[144:147], a[16:19], v[188:191]
    v_exp_f32 v213, v213
    v_mfma_f32_16x16x32_bf16 v[216:219], a[148:151], a[20:23], v[216:219]
    ds_read_b64_tr_b16 a[196:197], v17 offset:8192
    ds_read_b64_tr_b16 a[198:199], v17 offset:12288
    v_mfma_f32_16x16x32_bf16 v[216:219], a[152:155], a[24:27], v[216:219]
    v_exp_f32 v214, v214
    v_mfma_f32_16x16x32_bf16 v[216:219], a[156:159], a[28:31], v[216:219]
    ds_read_b64_tr_b16 a[200:201], v18 offset:8192
    ds_read_b64_tr_b16 a[202:203], v18 offset:12288
    v_mfma_f32_16x16x32_bf16 v[220:223], a[160:163], a[16:19], v[188:191]
    v_exp_f32 v215, v215
    v_mfma_f32_16x16x32_bf16 v[220:223], a[164:167], a[20:23], v[220:223]
    v_cvt_pk_bf16_f32 v226, v212, v213
    v_cvt_pk_bf16_f32 v227, v214, v215
    v_mfma_f32_16x16x32_bf16 v[220:223], a[168:171], a[24:27], v[220:223]
    ds_read_b64_tr_b16 a[204:205], v19 offset:8192
    ds_read_b64_tr_b16 a[206:207], v19 offset:12288
    ds_read_b64_tr_b16 a[176:177], v12 offset:8192
    v_mfma_f32_16x16x32_bf16 v[220:223], a[172:175], a[28:31], v[220:223]
    ds_read_b64_tr_b16 a[178:179], v12 offset:12288
    v_exp_f32 v216, v216
    s_waitcnt lgkmcnt(6)
    v_mfma_f32_16x16x32_bf16 a[96:99], a[184:187], v[224:227], a[96:99]
    v_exp_f32 v217, v217
    v_mfma_f32_16x16x32_bf16 v[88:91], v[224:227], a[188:191], v[88:91]
    ds_read_b64_tr_b16 a[180:181], v13 offset:8192
    ds_read_b64_tr_b16 a[182:183], v13 offset:12288
    v_mfma_f32_16x16x32_bf16 v[92:95], v[224:227], a[192:195], v[92:95]
    v_exp_f32 v218, v218
    v_mfma_f32_16x16x32_bf16 v[96:99], v[224:227], a[196:199], v[96:99]
    s_waitcnt lgkmcnt(0)
    buffer_load_dwordx4 v24, s[20:23], s71 offen offset:2048 lds
    v_mfma_f32_16x16x32_bf16 v[100:103], v[224:227], a[200:203], v[100:103]
    v_exp_f32 v219, v219
    v_mfma_f32_16x16x32_bf16 a[100:103], a[204:207], v[224:227], a[100:103]
    v_cvt_pk_bf16_f32 v228, v216, v217
    v_cvt_pk_bf16_f32 v229, v218, v219
    v_mfma_f32_16x16x32_bf16 v[40:43], a[176:179], v[224:227], v[40:43]
    v_exp_f32 v220, v220
    v_mfma_f32_16x16x32_bf16 v[44:47], a[180:183], v[224:227], v[44:47]
    buffer_load_dwordx4 v25, s[20:23], s71 offen offset:3072 lds
    v_mfma_f32_16x16x32_bf16 v[208:211], a[144:147], a[32:35], v[192:195]
    s_mov_b32 m0, s33
    v_exp_f32 v221, v221
    v_mfma_f32_16x16x32_bf16 v[208:211], a[148:151], a[36:39], v[208:211]
    buffer_load_dwordx4 v20, s[16:19], s72 offen lds
    v_mfma_f32_16x16x32_bf16 v[208:211], a[152:155], a[40:43], v[208:211]
    v_exp_f32 v222, v222
    v_mfma_f32_16x16x32_bf16 v[208:211], a[156:159], a[44:47], v[208:211]
    buffer_load_dwordx4 v21, s[16:19], s72 offen offset:1024 lds
    v_mfma_f32_16x16x32_bf16 v[212:215], a[160:163], a[32:35], v[192:195]
    v_exp_f32 v223, v223
    v_mfma_f32_16x16x32_bf16 v[212:215], a[164:167], a[36:39], v[212:215]
    v_cvt_pk_bf16_f32 v230, v220, v221
    v_cvt_pk_bf16_f32 v231, v222, v223
    v_mfma_f32_16x16x32_bf16 v[212:215], a[168:171], a[40:43], v[212:215]
    buffer_load_dwordx4 v22, s[16:19], s72 offen offset:2048 lds
    v_mfma_f32_16x16x32_bf16 v[212:215], a[172:175], a[44:47], v[212:215]
    v_exp_f32 v208, v208
    v_smfmac_f32_16x16x64_bf16 v[236:239], a[240:243], v[224:231], v6
    v_mfma_f32_16x16x32_bf16 a[104:107], a[184:187], v[228:231], a[104:107]
    v_exp_f32 v209, v209
    v_mfma_f32_16x16x32_bf16 v[104:107], v[228:231], a[188:191], v[104:107]
    buffer_load_dwordx4 v23, s[16:19], s72 offen offset:3072 lds
    v_mfma_f32_16x16x32_bf16 v[108:111], v[228:231], a[192:195], v[108:111]
    s_add_u32 m0, s33, 0x1000
    v_exp_f32 v210, v210
    v_mfma_f32_16x16x32_bf16 v[112:115], v[228:231], a[196:199], v[112:115]
    buffer_load_dwordx4 v20, s[16:19], s73 offen lds
    v_mfma_f32_16x16x32_bf16 v[116:119], v[228:231], a[200:203], v[116:119]
    v_exp_f32 v211, v211
    v_mfma_f32_16x16x32_bf16 a[108:111], a[204:207], v[228:231], a[108:111]
    v_cvt_pk_bf16_f32 v224, v208, v209
    v_cvt_pk_bf16_f32 v225, v210, v211
    v_mfma_f32_16x16x32_bf16 v[48:51], a[176:179], v[228:231], v[48:51]
    v_exp_f32 v212, v212
    v_mfma_f32_16x16x32_bf16 v[52:55], a[180:183], v[228:231], v[52:55]
    buffer_load_dwordx4 v21, s[16:19], s73 offen offset:1024 lds
    v_mfma_f32_16x16x32_bf16 v[216:219], a[144:147], a[48:51], v[196:199]
    v_exp_f32 v213, v213
    v_mfma_f32_16x16x32_bf16 v[216:219], a[148:151], a[52:55], v[216:219]
    buffer_load_dwordx4 v22, s[16:19], s73 offen offset:2048 lds
    v_mfma_f32_16x16x32_bf16 v[216:219], a[152:155], a[56:59], v[216:219]
    v_exp_f32 v214, v214
    v_mfma_f32_16x16x32_bf16 v[216:219], a[156:159], a[60:63], v[216:219]
    v_mfma_f32_16x16x32_bf16 v[220:223], a[160:163], a[48:51], v[196:199]
    v_exp_f32 v215, v215
    v_mfma_f32_16x16x32_bf16 v[220:223], a[164:167], a[52:55], v[220:223]
    v_cvt_pk_bf16_f32 v226, v212, v213
    v_cvt_pk_bf16_f32 v227, v214, v215
    v_mfma_f32_16x16x32_bf16 v[220:223], a[168:171], a[56:59], v[220:223]
    buffer_load_dwordx4 v23, s[16:19], s73 offen offset:3072 lds
    v_mfma_f32_16x16x32_bf16 v[220:223], a[172:175], a[60:63], v[220:223]
    v_exp_f32 v216, v216
    v_mfma_f32_16x16x32_bf16 a[112:115], a[184:187], v[224:227], a[112:115]
    v_exp_f32 v217, v217
    v_mfma_f32_16x16x32_bf16 v[120:123], v[224:227], a[188:191], v[120:123]
    v_mfma_f32_16x16x32_bf16 v[124:127], v[224:227], a[192:195], v[124:127]
    v_exp_f32 v218, v218
    v_mfma_f32_16x16x32_bf16 v[128:131], v[224:227], a[196:199], v[128:131]
    v_mfma_f32_16x16x32_bf16 v[132:135], v[224:227], a[200:203], v[132:135]
    v_exp_f32 v219, v219
    v_mfma_f32_16x16x32_bf16 a[116:119], a[204:207], v[224:227], a[116:119]
    v_cvt_pk_bf16_f32 v228, v216, v217
    v_cvt_pk_bf16_f32 v229, v218, v219
    v_mfma_f32_16x16x32_bf16 v[56:59], a[176:179], v[224:227], v[56:59]
    v_exp_f32 v220, v220
    v_mfma_f32_16x16x32_bf16 v[60:63], a[180:183], v[224:227], v[60:63]
    v_mfma_f32_16x16x32_bf16 v[208:211], a[144:147], a[64:67], v[200:203]
    v_exp_f32 v221, v221
    v_mfma_f32_16x16x32_bf16 v[208:211], a[148:151], a[68:71], v[208:211]
    v_mfma_f32_16x16x32_bf16 v[208:211], a[152:155], a[72:75], v[208:211]
    v_exp_f32 v222, v222
    v_mfma_f32_16x16x32_bf16 v[208:211], a[156:159], a[76:79], v[208:211]
    v_mfma_f32_16x16x32_bf16 v[212:215], a[160:163], a[64:67], v[200:203]
    v_exp_f32 v223, v223
    v_mfma_f32_16x16x32_bf16 v[212:215], a[164:167], a[68:71], v[212:215]
    v_cvt_pk_bf16_f32 v230, v220, v221
    v_cvt_pk_bf16_f32 v231, v222, v223
    v_mfma_f32_16x16x32_bf16 v[212:215], a[168:171], a[72:75], v[212:215]
    v_mfma_f32_16x16x32_bf16 v[212:215], a[172:175], a[76:79], v[212:215]
    v_exp_f32 v208, v208
    v_smfmac_f32_16x16x64_bf16 v[244:247], a[240:243], v[224:231], v6
    v_mfma_f32_16x16x32_bf16 a[120:123], a[184:187], v[228:231], a[120:123]
    v_exp_f32 v209, v209
    v_mfma_f32_16x16x32_bf16 v[136:139], v[228:231], a[188:191], v[136:139]
    v_mfma_f32_16x16x32_bf16 v[140:143], v[228:231], a[192:195], v[140:143]
    v_exp_f32 v210, v210
    v_mfma_f32_16x16x32_bf16 v[144:147], v[228:231], a[196:199], v[144:147]
    v_mfma_f32_16x16x32_bf16 v[148:151], v[228:231], a[200:203], v[148:151]
    v_exp_f32 v211, v211
    v_mfma_f32_16x16x32_bf16 a[124:127], a[204:207], v[228:231], a[124:127]
    v_cvt_pk_bf16_f32 v224, v208, v209
    v_cvt_pk_bf16_f32 v225, v210, v211
    v_mfma_f32_16x16x32_bf16 v[64:67], a[176:179], v[228:231], v[64:67]
    s_waitcnt vmcnt(16)
    v_exp_f32 v212, v212
    v_mfma_f32_16x16x32_bf16 v[68:71], a[180:183], v[228:231], v[68:71]
    v_mfma_f32_16x16x32_bf16 v[216:219], a[144:147], a[80:83], v[204:207]
    v_exp_f32 v213, v213
    v_mfma_f32_16x16x32_bf16 v[216:219], a[148:151], a[84:87], v[216:219]
    ds_read_b128 a[144:147], v8 offset:16384
    ds_read_b128 a[148:151], v9 offset:16384
    v_mfma_f32_16x16x32_bf16 v[216:219], a[152:155], a[88:91], v[216:219]
    v_exp_f32 v214, v214
    v_mfma_f32_16x16x32_bf16 v[216:219], a[156:159], a[92:95], v[216:219]
    ds_read_b128 a[152:155], v10 offset:16384
    ds_read_b128 a[156:159], v11 offset:16384
    v_mfma_f32_16x16x32_bf16 v[220:223], a[160:163], a[80:83], v[204:207]
    v_exp_f32 v215, v215
    v_mfma_f32_16x16x32_bf16 v[220:223], a[164:167], a[84:87], v[220:223]
    v_cvt_pk_bf16_f32 v226, v212, v213
    v_cvt_pk_bf16_f32 v227, v214, v215
    v_mfma_f32_16x16x32_bf16 v[220:223], a[168:171], a[88:91], v[220:223]
    ds_read_b128 a[160:163], v8 offset:20480
    ds_read_b128 a[164:167], v9 offset:20480
    v_mfma_f32_16x16x32_bf16 v[220:223], a[172:175], a[92:95], v[220:223]
    v_exp_f32 v216, v216
    v_mfma_f32_16x16x32_bf16 a[128:131], a[184:187], v[224:227], a[128:131]
    s_add_u32 m0, s33, 0x2000
    v_exp_f32 v217, v217
    v_mfma_f32_16x16x32_bf16 v[152:155], v[224:227], a[188:191], v[152:155]
    ds_read_b128 a[168:171], v10 offset:20480
    ds_read_b128 a[172:175], v11 offset:20480
    v_mfma_f32_16x16x32_bf16 v[156:159], v[224:227], a[192:195], v[156:159]
    v_exp_f32 v218, v218
    v_mfma_f32_16x16x32_bf16 v[160:163], v[224:227], a[196:199], v[160:163]
    buffer_load_dwordx4 v24, s[20:23], s72 offen lds
    v_mfma_f32_16x16x32_bf16 v[164:167], v[224:227], a[200:203], v[164:167]
    v_exp_f32 v219, v219
    v_mfma_f32_16x16x32_bf16 v[240:243], v[224:227], a[204:207], v[240:243]
    v_cvt_pk_bf16_f32 v228, v216, v217
    v_cvt_pk_bf16_f32 v229, v218, v219
    v_mfma_f32_16x16x32_bf16 v[72:75], a[176:179], v[224:227], v[72:75]
    v_exp_f32 v220, v220
    v_mfma_f32_16x16x32_bf16 v[76:79], a[180:183], v[224:227], v[76:79]
    s_waitcnt lgkmcnt(0)
    buffer_load_dwordx4 v25, s[20:23], s72 offen offset:1024 lds
    v_mfma_f32_16x16x32_bf16 v[208:211], a[144:147], a[0:3], v[184:187]
    v_exp_f32 v221, v221
    v_mfma_f32_16x16x32_bf16 v[208:211], a[148:151], a[4:7], v[208:211]
    buffer_load_dwordx4 v24, s[20:23], s72 offen offset:2048 lds
    v_mfma_f32_16x16x32_bf16 v[208:211], a[152:155], a[8:11], v[208:211]
L_t6:
    s_cbranch_vccnz L_tr
    s_bfe_u32 s74, s42, 0x4001c
    v_exp_f32 v222, v222
    v_mfma_f32_16x16x32_bf16 v[208:211], a[156:159], a[12:15], v[208:211]
    buffer_load_dwordx4 v25, s[20:23], s72 offen offset:3072 lds
    v_mfma_f32_16x16x32_bf16 v[212:215], a[160:163], a[0:3], v[184:187]
    s_mul_i32 s74, s74, 0x2000
    v_exp_f32 v223, v223
    v_mfma_f32_16x16x32_bf16 v[212:215], a[164:167], a[4:7], v[212:215]
    s_add_u32 s74, s74, s44
    v_cvt_pk_bf16_f32 v230, v220, v221
    v_cvt_pk_bf16_f32 v231, v222, v223
    v_mfma_f32_16x16x32_bf16 v[212:215], a[168:171], a[8:11], v[212:215]
    s_waitcnt vmcnt(12)
    v_mfma_f32_16x16x32_bf16 v[212:215], a[172:175], a[12:15], v[212:215]
    s_add_u32 m0, s33, 0x3000
    v_exp_f32 v208, v208
    v_smfmac_f32_16x16x64_bf16 v[252:255], a[240:243], v[224:231], v6
    buffer_load_dwordx4 v24, s[20:23], s73 offen lds
    v_mfma_f32_16x16x32_bf16 v[232:235], v[228:231], a[184:187], v[232:235]
    s_and_b32 s74, s74, 0x1ffff
    v_exp_f32 v209, v209
    v_mfma_f32_16x16x32_bf16 v[168:171], v[228:231], a[188:191], v[168:171]
    s_add_u32 s75, s74, 0x1000
    ds_read_b64_tr_b16 a[184:185], v14 offset:24576
    ds_read_b64_tr_b16 a[186:187], v14 offset:28672
    v_mfma_f32_16x16x32_bf16 v[172:175], v[228:231], a[192:195], v[172:175]
    v_exp_f32 v210, v210
    v_mfma_f32_16x16x32_bf16 v[176:179], v[228:231], a[196:199], v[176:179]
    ds_read_b64_tr_b16 a[188:189], v15 offset:24576
    ds_read_b64_tr_b16 a[190:191], v15 offset:28672
    buffer_load_dwordx4 v25, s[20:23], s73 offen offset:1024 lds
    v_mfma_f32_16x16x32_bf16 v[180:183], v[228:231], a[200:203], v[180:183]
    v_exp_f32 v211, v211
    v_mfma_f32_16x16x32_bf16 v[248:251], v[228:231], a[204:207], v[248:251]
    v_cvt_pk_bf16_f32 v224, v208, v209
    v_cvt_pk_bf16_f32 v225, v210, v211
    v_mfma_f32_16x16x32_bf16 v[80:83], a[176:179], v[228:231], v[80:83]
    v_exp_f32 v212, v212
    v_mfma_f32_16x16x32_bf16 v[84:87], a[180:183], v[228:231], v[84:87]
    ds_read_b64_tr_b16 a[192:193], v16 offset:24576
    ds_read_b64_tr_b16 a[194:195], v16 offset:28672
    v_mfma_f32_16x16x32_bf16 v[216:219], a[144:147], a[16:19], v[188:191]
    v_exp_f32 v213, v213
    v_mfma_f32_16x16x32_bf16 v[216:219], a[148:151], a[20:23], v[216:219]
    ds_read_b64_tr_b16 a[196:197], v17 offset:24576
    ds_read_b64_tr_b16 a[198:199], v17 offset:28672
    v_mfma_f32_16x16x32_bf16 v[216:219], a[152:155], a[24:27], v[216:219]
    v_exp_f32 v214, v214
    v_mfma_f32_16x16x32_bf16 v[216:219], a[156:159], a[28:31], v[216:219]
    ds_read_b64_tr_b16 a[200:201], v18 offset:24576
    ds_read_b64_tr_b16 a[202:203], v18 offset:28672
    v_mfma_f32_16x16x32_bf16 v[220:223], a[160:163], a[16:19], v[188:191]
    v_exp_f32 v215, v215
    v_mfma_f32_16x16x32_bf16 v[220:223], a[164:167], a[20:23], v[220:223]
    v_cvt_pk_bf16_f32 v226, v212, v213
    v_cvt_pk_bf16_f32 v227, v214, v215
    v_mfma_f32_16x16x32_bf16 v[220:223], a[168:171], a[24:27], v[220:223]
    ds_read_b64_tr_b16 a[204:205], v19 offset:24576
    ds_read_b64_tr_b16 a[206:207], v19 offset:28672
    ds_read_b64_tr_b16 a[176:177], v12 offset:24576
    v_mfma_f32_16x16x32_bf16 v[220:223], a[172:175], a[28:31], v[220:223]
    ds_read_b64_tr_b16 a[178:179], v12 offset:28672
    v_exp_f32 v216, v216
    s_waitcnt lgkmcnt(6)
    v_mfma_f32_16x16x32_bf16 a[96:99], a[184:187], v[224:227], a[96:99]
    v_exp_f32 v217, v217
    v_mfma_f32_16x16x32_bf16 v[88:91], v[224:227], a[188:191], v[88:91]
    ds_read_b64_tr_b16 a[180:181], v13 offset:24576
    ds_read_b64_tr_b16 a[182:183], v13 offset:28672
    v_mfma_f32_16x16x32_bf16 v[92:95], v[224:227], a[192:195], v[92:95]
    v_exp_f32 v218, v218
    v_mfma_f32_16x16x32_bf16 v[96:99], v[224:227], a[196:199], v[96:99]
    s_waitcnt lgkmcnt(0)
    buffer_load_dwordx4 v24, s[20:23], s73 offen offset:2048 lds
    v_mfma_f32_16x16x32_bf16 v[100:103], v[224:227], a[200:203], v[100:103]
    v_exp_f32 v219, v219
    v_mfma_f32_16x16x32_bf16 a[100:103], a[204:207], v[224:227], a[100:103]
    v_cvt_pk_bf16_f32 v228, v216, v217
    v_cvt_pk_bf16_f32 v229, v218, v219
    v_mfma_f32_16x16x32_bf16 v[40:43], a[176:179], v[224:227], v[40:43]
    v_exp_f32 v220, v220
    v_mfma_f32_16x16x32_bf16 v[44:47], a[180:183], v[224:227], v[44:47]
    buffer_load_dwordx4 v25, s[20:23], s73 offen offset:3072 lds
    v_mfma_f32_16x16x32_bf16 v[208:211], a[144:147], a[32:35], v[192:195]
    v_exp_f32 v221, v221
    v_mfma_f32_16x16x32_bf16 v[208:211], a[148:151], a[36:39], v[208:211]
    v_mfma_f32_16x16x32_bf16 v[208:211], a[152:155], a[40:43], v[208:211]
    v_exp_f32 v222, v222
    v_mfma_f32_16x16x32_bf16 v[208:211], a[156:159], a[44:47], v[208:211]
    v_mfma_f32_16x16x32_bf16 v[212:215], a[160:163], a[32:35], v[192:195]
    v_exp_f32 v223, v223
    v_mfma_f32_16x16x32_bf16 v[212:215], a[164:167], a[36:39], v[212:215]
    v_cvt_pk_bf16_f32 v230, v220, v221
    v_cvt_pk_bf16_f32 v231, v222, v223
    v_mfma_f32_16x16x32_bf16 v[212:215], a[168:171], a[40:43], v[212:215]
    v_mfma_f32_16x16x32_bf16 v[212:215], a[172:175], a[44:47], v[212:215]
    v_exp_f32 v208, v208
    v_smfmac_f32_16x16x64_bf16 v[236:239], a[240:243], v[224:231], v6
    v_mfma_f32_16x16x32_bf16 a[104:107], a[184:187], v[228:231], a[104:107]
    v_exp_f32 v209, v209
    v_mfma_f32_16x16x32_bf16 v[104:107], v[228:231], a[188:191], v[104:107]
    v_mfma_f32_16x16x32_bf16 v[108:111], v[228:231], a[192:195], v[108:111]
    v_exp_f32 v210, v210
    v_mfma_f32_16x16x32_bf16 v[112:115], v[228:231], a[196:199], v[112:115]
    v_mfma_f32_16x16x32_bf16 v[116:119], v[228:231], a[200:203], v[116:119]
    v_exp_f32 v211, v211
    v_mfma_f32_16x16x32_bf16 a[108:111], a[204:207], v[228:231], a[108:111]
    v_cvt_pk_bf16_f32 v224, v208, v209
    v_cvt_pk_bf16_f32 v225, v210, v211
    v_mfma_f32_16x16x32_bf16 v[48:51], a[176:179], v[228:231], v[48:51]
    v_exp_f32 v212, v212
    v_mfma_f32_16x16x32_bf16 v[52:55], a[180:183], v[228:231], v[52:55]
    v_mfma_f32_16x16x32_bf16 v[216:219], a[144:147], a[48:51], v[196:199]
    v_exp_f32 v213, v213
    v_mfma_f32_16x16x32_bf16 v[216:219], a[148:151], a[52:55], v[216:219]
    v_mfma_f32_16x16x32_bf16 v[216:219], a[152:155], a[56:59], v[216:219]
    v_exp_f32 v214, v214
    v_mfma_f32_16x16x32_bf16 v[216:219], a[156:159], a[60:63], v[216:219]
    v_mfma_f32_16x16x32_bf16 v[220:223], a[160:163], a[48:51], v[196:199]
    v_exp_f32 v215, v215
    v_mfma_f32_16x16x32_bf16 v[220:223], a[164:167], a[52:55], v[220:223]
    v_cvt_pk_bf16_f32 v226, v212, v213
    v_cvt_pk_bf16_f32 v227, v214, v215
    v_mfma_f32_16x16x32_bf16 v[220:223], a[168:171], a[56:59], v[220:223]
    v_mfma_f32_16x16x32_bf16 v[220:223], a[172:175], a[60:63], v[220:223]
    v_exp_f32 v216, v216
    v_mfma_f32_16x16x32_bf16 a[112:115], a[184:187], v[224:227], a[112:115]
    s_add_u32 m0, s33, 0x4000
    v_exp_f32 v217, v217
    v_mfma_f32_16x16x32_bf16 v[120:123], v[224:227], a[188:191], v[120:123]
    buffer_load_dwordx4 v20, s[16:19], s74 offen lds
    v_mfma_f32_16x16x32_bf16 v[124:127], v[224:227], a[192:195], v[124:127]
    v_exp_f32 v218, v218
    v_mfma_f32_16x16x32_bf16 v[128:131], v[224:227], a[196:199], v[128:131]
    buffer_load_dwordx4 v21, s[16:19], s74 offen offset:1024 lds
    v_mfma_f32_16x16x32_bf16 v[132:135], v[224:227], a[200:203], v[132:135]
    v_exp_f32 v219, v219
    v_mfma_f32_16x16x32_bf16 a[116:119], a[204:207], v[224:227], a[116:119]
    v_cvt_pk_bf16_f32 v228, v216, v217
    v_cvt_pk_bf16_f32 v229, v218, v219
    v_mfma_f32_16x16x32_bf16 v[56:59], a[176:179], v[224:227], v[56:59]
    v_exp_f32 v220, v220
    v_mfma_f32_16x16x32_bf16 v[60:63], a[180:183], v[224:227], v[60:63]
    buffer_load_dwordx4 v22, s[16:19], s74 offen offset:2048 lds
    v_mfma_f32_16x16x32_bf16 v[208:211], a[144:147], a[64:67], v[200:203]
    v_exp_f32 v221, v221
    v_mfma_f32_16x16x32_bf16 v[208:211], a[148:151], a[68:71], v[208:211]
    v_mfma_f32_16x16x32_bf16 v[208:211], a[152:155], a[72:75], v[208:211]
    v_exp_f32 v222, v222
    v_mfma_f32_16x16x32_bf16 v[208:211], a[156:159], a[76:79], v[208:211]
    buffer_load_dwordx4 v23, s[16:19], s74 offen offset:3072 lds
    v_mfma_f32_16x16x32_bf16 v[212:215], a[160:163], a[64:67], v[200:203]
    v_exp_f32 v223, v223
    v_mfma_f32_16x16x32_bf16 v[212:215], a[164:167], a[68:71], v[212:215]
    v_cvt_pk_bf16_f32 v230, v220, v221
    v_cvt_pk_bf16_f32 v231, v222, v223
    v_mfma_f32_16x16x32_bf16 v[212:215], a[168:171], a[72:75], v[212:215]
    v_mfma_f32_16x16x32_bf16 v[212:215], a[172:175], a[76:79], v[212:215]
    s_add_u32 m0, s33, 0x5000
    v_exp_f32 v208, v208
    v_smfmac_f32_16x16x64_bf16 v[244:247], a[240:243], v[224:231], v6
    v_mfma_f32_16x16x32_bf16 a[120:123], a[184:187], v[228:231], a[120:123]
    v_exp_f32 v209, v209
    v_mfma_f32_16x16x32_bf16 v[136:139], v[228:231], a[188:191], v[136:139]
    buffer_load_dwordx4 v20, s[16:19], s75 offen lds
    v_mfma_f32_16x16x32_bf16 v[140:143], v[228:231], a[192:195], v[140:143]
    v_exp_f32 v210, v210
    v_mfma_f32_16x16x32_bf16 v[144:147], v[228:231], a[196:199], v[144:147]
    buffer_load_dwordx4 v21, s[16:19], s75 offen offset:1024 lds
    v_mfma_f32_16x16x32_bf16 v[148:151], v[228:231], a[200:203], v[148:151]
    v_exp_f32 v211, v211
    v_mfma_f32_16x16x32_bf16 a[124:127], a[204:207], v[228:231], a[124:127]
    v_cvt_pk_bf16_f32 v224, v208, v209
    v_cvt_pk_bf16_f32 v225, v210, v211
    v_mfma_f32_16x16x32_bf16 v[64:67], a[176:179], v[228:231], v[64:67]
    s_waitcnt vmcnt(14)
    v_exp_f32 v212, v212
    v_mfma_f32_16x16x32_bf16 v[68:71], a[180:183], v[228:231], v[68:71]
    buffer_load_dwordx4 v22, s[16:19], s75 offen offset:2048 lds
    v_mfma_f32_16x16x32_bf16 v[216:219], a[144:147], a[80:83], v[204:207]
    v_exp_f32 v213, v213
    v_mfma_f32_16x16x32_bf16 v[216:219], a[148:151], a[84:87], v[216:219]
    ds_read_b128 a[144:147], v8
    ds_read_b128 a[148:151], v9
    v_mfma_f32_16x16x32_bf16 v[216:219], a[152:155], a[88:91], v[216:219]
    v_exp_f32 v214, v214
    v_mfma_f32_16x16x32_bf16 v[216:219], a[156:159], a[92:95], v[216:219]
    ds_read_b128 a[152:155], v10
    ds_read_b128 a[156:159], v11
    v_mfma_f32_16x16x32_bf16 v[220:223], a[160:163], a[80:83], v[204:207]
    v_exp_f32 v215, v215
    v_mfma_f32_16x16x32_bf16 v[220:223], a[164:167], a[84:87], v[220:223]
    v_cvt_pk_bf16_f32 v226, v212, v213
    v_cvt_pk_bf16_f32 v227, v214, v215
    v_mfma_f32_16x16x32_bf16 v[220:223], a[168:171], a[88:91], v[220:223]
    ds_read_b128 a[160:163], v8 offset:4096
    ds_read_b128 a[164:167], v9 offset:4096
    v_mfma_f32_16x16x32_bf16 v[220:223], a[172:175], a[92:95], v[220:223]
    v_exp_f32 v216, v216
    v_mfma_f32_16x16x32_bf16 a[128:131], a[184:187], v[224:227], a[128:131]
    v_exp_f32 v217, v217
    v_mfma_f32_16x16x32_bf16 v[152:155], v[224:227], a[188:191], v[152:155]
    ds_read_b128 a[168:171], v10 offset:4096
    ds_read_b128 a[172:175], v11 offset:4096
    v_mfma_f32_16x16x32_bf16 v[156:159], v[224:227], a[192:195], v[156:159]
    v_exp_f32 v218, v218
    v_mfma_f32_16x16x32_bf16 v[160:163], v[224:227], a[196:199], v[160:163]
    buffer_load_dwordx4 v23, s[16:19], s75 offen offset:3072 lds
    v_mfma_f32_16x16x32_bf16 v[164:167], v[224:227], a[200:203], v[164:167]
    s_add_u32 m0, s33, 0x6000
    v_exp_f32 v219, v219
    v_mfma_f32_16x16x32_bf16 v[240:243], v[224:227], a[204:207], v[240:243]
    v_cvt_pk_bf16_f32 v228, v216, v217
    v_cvt_pk_bf16_f32 v229, v218, v219
    v_mfma_f32_16x16x32_bf16 v[72:75], a[176:179], v[224:227], v[72:75]
    v_exp_f32 v220, v220
    v_mfma_f32_16x16x32_bf16 v[76:79], a[180:183], v[224:227], v[76:79]
    s_waitcnt lgkmcnt(0)
    buffer_load_dwordx4 v24, s[20:23], s74 offen lds
    v_mfma_f32_16x16x32_bf16 v[208:211], a[144:147], a[0:3], v[184:187]
    v_exp_f32 v221, v221
    v_mfma_f32_16x16x32_bf16 v[208:211], a[148:151], a[4:7], v[208:211]
    buffer_load_dwordx4 v25, s[20:23], s74 offen offset:1024 lds
    v_mfma_f32_16x16x32_bf16 v[208:211], a[152:155], a[8:11], v[208:211]
    v_exp_f32 v222, v222
    v_mfma_f32_16x16x32_bf16 v[208:211], a[156:159], a[12:15], v[208:211]
    buffer_load_dwordx4 v24, s[20:23], s74 offen offset:2048 lds
    v_mfma_f32_16x16x32_bf16 v[212:215], a[160:163], a[0:3], v[184:187]
    v_exp_f32 v223, v223
    v_mfma_f32_16x16x32_bf16 v[212:215], a[164:167], a[4:7], v[212:215]
    v_cvt_pk_bf16_f32 v230, v220, v221
    v_cvt_pk_bf16_f32 v231, v222, v223
    v_mfma_f32_16x16x32_bf16 v[212:215], a[168:171], a[8:11], v[212:215]
    s_waitcnt vmcnt(11)
    buffer_load_dwordx4 v25, s[20:23], s74 offen offset:3072 lds
    v_mfma_f32_16x16x32_bf16 v[212:215], a[172:175], a[12:15], v[212:215]
    s_add_u32 m0, s33, 0x7000
    v_exp_f32 v208, v208
    v_smfmac_f32_16x16x64_bf16 v[252:255], a[240:243], v[224:231], v6
    buffer_load_dwordx4 v24, s[20:23], s75 offen lds
    v_mfma_f32_16x16x32_bf16 v[232:235], v[228:231], a[184:187], v[232:235]
    v_exp_f32 v209, v209
    v_mfma_f32_16x16x32_bf16 v[168:171], v[228:231], a[188:191], v[168:171]
    ds_read_b64_tr_b16 a[184:185], v14 offset:8192
    ds_read_b64_tr_b16 a[186:187], v14 offset:12288
    v_mfma_f32_16x16x32_bf16 v[172:175], v[228:231], a[192:195], v[172:175]
    v_exp_f32 v210, v210
    v_mfma_f32_16x16x32_bf16 v[176:179], v[228:231], a[196:199], v[176:179]
    ds_read_b64_tr_b16 a[188:189], v15 offset:8192
    ds_read_b64_tr_b16 a[190:191], v15 offset:12288
    buffer_load_dwordx4 v25, s[20:23], s75 offen offset:1024 lds
    v_mfma_f32_16x16x32_bf16 v[180:183], v[228:231], a[200:203], v[180:183]
    v_exp_f32 v211, v211
    v_mfma_f32_16x16x32_bf16 v[248:251], v[228:231], a[204:207], v[248:251]
    v_cvt_pk_bf16_f32 v224, v208, v209
    v_cvt_pk_bf16_f32 v225, v210, v211
    v_mfma_f32_16x16x32_bf16 v[80:83], a[176:179], v[228:231], v[80:83]
    v_exp_f32 v212, v212
    v_mfma_f32_16x16x32_bf16 v[84:87], a[180:183], v[228:231], v[84:87]
    ds_read_b64_tr_b16 a[192:193], v16 offset:8192
    ds_read_b64_tr_b16 a[194:195], v16 offset:12288
    v_mfma_f32_16x16x32_bf16 v[216:219], a[144:147], a[16:19], v[188:191]
    v_exp_f32 v213, v213
    v_mfma_f32_16x16x32_bf16 v[216:219], a[148:151], a[20:23], v[216:219]
    ds_read_b64_tr_b16 a[196:197], v17 offset:8192
    ds_read_b64_tr_b16 a[198:199], v17 offset:12288
    v_mfma_f32_16x16x32_bf16 v[216:219], a[152:155], a[24:27], v[216:219]
    v_exp_f32 v214, v214
    v_mfma_f32_16x16x32_bf16 v[216:219], a[156:159], a[28:31], v[216:219]
    ds_read_b64_tr_b16 a[200:201], v18 offset:8192
    ds_read_b64_tr_b16 a[202:203], v18 offset:12288
    v_mfma_f32_16x16x32_bf16 v[220:223], a[160:163], a[16:19], v[188:191]
    v_exp_f32 v215, v215
    v_mfma_f32_16x16x32_bf16 v[220:223], a[164:167], a[20:23], v[220:223]
    v_cvt_pk_bf16_f32 v226, v212, v213
    v_cvt_pk_bf16_f32 v227, v214, v215
    v_mfma_f32_16x16x32_bf16 v[220:223], a[168:171], a[24:27], v[220:223]
    ds_read_b64_tr_b16 a[204:205], v19 offset:8192
    ds_read_b64_tr_b16 a[206:207], v19 offset:12288
    ds_read_b64_tr_b16 a[176:177], v12 offset:8192
    v_mfma_f32_16x16x32_bf16 v[220:223], a[172:175], a[28:31], v[220:223]
    ds_read_b64_tr_b16 a[178:179], v12 offset:12288
    v_exp_f32 v216, v216
    s_waitcnt lgkmcnt(6)
    v_mfma_f32_16x16x32_bf16 a[96:99], a[184:187], v[224:227], a[96:99]
    v_exp_f32 v217, v217
    v_mfma_f32_16x16x32_bf16 v[88:91], v[224:227], a[188:191], v[88:91]
    ds_read_b64_tr_b16 a[180:181], v13 offset:8192
    ds_read_b64_tr_b16 a[182:183], v13 offset:12288
    v_mfma_f32_16x16x32_bf16 v[92:95], v[224:227], a[192:195], v[92:95]
    v_exp_f32 v218, v218
    v_mfma_f32_16x16x32_bf16 v[96:99], v[224:227], a[196:199], v[96:99]
    s_waitcnt lgkmcnt(0)
    buffer_load_dwordx4 v24, s[20:23], s75 offen offset:2048 lds
    v_mfma_f32_16x16x32_bf16 v[100:103], v[224:227], a[200:203], v[100:103]
    v_exp_f32 v219, v219
    v_mfma_f32_16x16x32_bf16 a[100:103], a[204:207], v[224:227], a[100:103]
    v_cvt_pk_bf16_f32 v228, v216, v217
    v_cvt_pk_bf16_f32 v229, v218, v219
    v_mfma_f32_16x16x32_bf16 v[40:43], a[176:179], v[224:227], v[40:43]
    v_exp_f32 v220, v220
    v_mfma_f32_16x16x32_bf16 v[44:47], a[180:183], v[224:227], v[44:47]
    buffer_load_dwordx4 v25, s[20:23], s75 offen offset:3072 lds
    v_mfma_f32_16x16x32_bf16 v[208:211], a[144:147], a[32:35], v[192:195]
    v_exp_f32 v221, v221
    v_mfma_f32_16x16x32_bf16 v[208:211], a[148:151], a[36:39], v[208:211]
    v_and_b32 v4, 1, v0
    v_mul_u32_u24 v39, 0x1b20, v4
    v_mfma_f32_16x16x32_bf16 v[208:211], a[152:155], a[40:43], v[208:211]
    v_exp_f32 v222, v222
    v_mfma_f32_16x16x32_bf16 v[208:211], a[156:159], a[44:47], v[208:211]
    v_bfe_u32 v4, v0, 1, 1
    v_mul_u32_u24 v4, 0x3680, v4
    v_mfma_f32_16x16x32_bf16 v[212:215], a[160:163], a[32:35], v[192:195]
    v_exp_f32 v223, v223
    v_mfma_f32_16x16x32_bf16 v[212:215], a[164:167], a[36:39], v[212:215]
    v_cvt_pk_bf16_f32 v230, v220, v221
    v_cvt_pk_bf16_f32 v231, v222, v223
    v_mfma_f32_16x16x32_bf16 v[212:215], a[168:171], a[40:43], v[212:215]
    v_add_u32 v39, v39, v4
    v_bfe_u32 v4, v0, 2, 2
    v_mfma_f32_16x16x32_bf16 v[212:215], a[172:175], a[44:47], v[212:215]
    v_exp_f32 v208, v208
    v_smfmac_f32_16x16x64_bf16 v[236:239], a[240:243], v[224:231], v6
    v_lshl_add_u32 v39, v4, 6, v39
    v_mfma_f32_16x16x32_bf16 a[104:107], a[184:187], v[228:231], a[104:107]
    v_exp_f32 v209, v209
    v_mfma_f32_16x16x32_bf16 v[104:107], v[228:231], a[188:191], v[104:107]
    v_lshrrev_b32 v4, 4, v0
    v_lshl_add_u32 v39, v4, 4, v39
    v_mfma_f32_16x16x32_bf16 v[108:111], v[228:231], a[192:195], v[108:111]
    s_mov_b32 m0, s33
    v_exp_f32 v210, v210
    v_mfma_f32_16x16x32_bf16 v[112:115], v[228:231], a[196:199], v[112:115]
    v_add_u32 v1, s33, v27
    v_add_u32 v2, s33, v26
    v_mfma_f32_16x16x32_bf16 v[116:119], v[228:231], a[200:203], v[116:119]
    s_xor_b32 s38, s32, 1
    v_exp_f32 v211, v211
    v_mfma_f32_16x16x32_bf16 a[108:111], a[204:207], v[228:231], a[108:111]
    s_mul_i32 s38, s38, 0xa000
    v_cvt_pk_bf16_f32 v224, v208, v209
    v_cvt_pk_bf16_f32 v225, v210, v211
    v_mfma_f32_16x16x32_bf16 v[48:51], a[176:179], v[228:231], v[48:51]
    v_exp_f32 v212, v212
    v_mfma_f32_16x16x32_bf16 v[52:55], a[180:183], v[228:231], v[52:55]
    v_add_u32 v35, s38, v26
    v_add_u32 v31, s38, v39
    v_mfma_f32_16x16x32_bf16 v[216:219], a[144:147], a[48:51], v[196:199]
    v_exp_f32 v213, v213
    v_mfma_f32_16x16x32_bf16 v[216:219], a[148:151], a[52:55], v[216:219]
    v_add_u32 v30, s38, v27
    v_mfma_f32_16x16x32_bf16 v[216:219], a[152:155], a[56:59], v[216:219]
    s_xor_b32 s38, s32, 2
    v_exp_f32 v214, v214
    v_mfma_f32_16x16x32_bf16 v[216:219], a[156:159], a[60:63], v[216:219]
    s_mul_i32 s38, s38, 0xa000
    v_add_u32 v36, s38, v26
    v_add_u32 v32, s38, v39
    v_mfma_f32_16x16x32_bf16 v[220:223], a[160:163], a[48:51], v[196:199]
    s_xor_b32 s38, s32, 3
    v_exp_f32 v215, v215
    v_mfma_f32_16x16x32_bf16 v[220:223], a[164:167], a[52:55], v[220:223]
    s_mul_i32 s38, s38, 0xa000
    v_cvt_pk_bf16_f32 v226, v212, v213
    v_cvt_pk_bf16_f32 v227, v214, v215
    v_mfma_f32_16x16x32_bf16 v[220:223], a[168:171], a[56:59], v[220:223]
    v_add_u32 v37, s38, v26
    v_add_u32 v33, s38, v39
    v_mfma_f32_16x16x32_bf16 v[220:223], a[172:175], a[60:63], v[220:223]
    v_exp_f32 v216, v216
    v_mfma_f32_16x16x32_bf16 a[112:115], a[184:187], v[224:227], a[112:115]
    v_exp_f32 v217, v217
    v_mfma_f32_16x16x32_bf16 v[120:123], v[224:227], a[188:191], v[120:123]
    v_add_u32 v38, s38, v27
    v_mfma_f32_16x16x32_bf16 v[124:127], v[224:227], a[192:195], v[124:127]
    s_mov_b32 s53, 0x1000
    v_exp_f32 v218, v218
    v_mfma_f32_16x16x32_bf16 v[128:131], v[224:227], a[196:199], v[128:131]
    s_mov_b32 s54, 0x2000
    v_mfma_f32_16x16x32_bf16 v[132:135], v[224:227], a[200:203], v[132:135]
    s_mov_b32 s55, 0x3000
    v_exp_f32 v219, v219
    v_mfma_f32_16x16x32_bf16 a[116:119], a[204:207], v[224:227], a[116:119]
    s_mov_b32 s56, 0x4000
    v_cvt_pk_bf16_f32 v228, v216, v217
    v_cvt_pk_bf16_f32 v229, v218, v219
    v_mfma_f32_16x16x32_bf16 v[56:59], a[176:179], v[224:227], v[56:59]
    s_mov_b32 s57, 0x5000
    v_exp_f32 v220, v220
    v_mfma_f32_16x16x32_bf16 v[60:63], a[180:183], v[224:227], v[60:63]
    v_lshlrev_b32 v3, 3, v26
    v_bfe_u32 v4, v0, 4, 1
    v_mfma_f32_16x16x32_bf16 v[208:211], a[144:147], a[64:67], v[200:203]
    v_exp_f32 v221, v221
    v_mfma_f32_16x16x32_bf16 v[208:211], a[148:151], a[68:71], v[208:211]
    v_lshl_add_u32 v3, v4, 5, v3
    v_lshrrev_b32 v4, 5, v0
    v_mfma_f32_16x16x32_bf16 v[208:211], a[152:155], a[72:75], v[208:211]
    v_exp_f32 v222, v222
    v_mfma_f32_16x16x32_bf16 v[208:211], a[156:159], a[76:79], v[208:211]
    s_lshl_b32 s39, s32, 6
    v_lshl_add_u32 v3, v4, 4, v3
    v_add_u32 v3, s39, v3
    v_mfma_f32_16x16x32_bf16 v[212:215], a[160:163], a[64:67], v[200:203]
    v_exp_f32 v223, v223
    v_mfma_f32_16x16x32_bf16 v[212:215], a[164:167], a[68:71], v[212:215]
    v_cvt_pk_bf16_f32 v230, v220, v221
    v_cvt_pk_bf16_f32 v231, v222, v223
    v_mfma_f32_16x16x32_bf16 v[212:215], a[168:171], a[72:75], v[212:215]
    v_mfma_f32_16x16x32_bf16 v[212:215], a[172:175], a[76:79], v[212:215]
    v_exp_f32 v208, v208
    v_smfmac_f32_16x16x64_bf16 v[244:247], a[240:243], v[224:231], v6
    v_mfma_f32_16x16x32_bf16 a[120:123], a[184:187], v[228:231], a[120:123]
    v_exp_f32 v209, v209
    v_mfma_f32_16x16x32_bf16 v[136:139], v[228:231], a[188:191], v[136:139]
    v_mfma_f32_16x16x32_bf16 v[140:143], v[228:231], a[192:195], v[140:143]
    v_exp_f32 v210, v210
    v_mfma_f32_16x16x32_bf16 v[144:147], v[228:231], a[196:199], v[144:147]
    v_mfma_f32_16x16x32_bf16 v[148:151], v[228:231], a[200:203], v[148:151]
    v_exp_f32 v211, v211
    v_mfma_f32_16x16x32_bf16 a[124:127], a[204:207], v[228:231], a[124:127]
    v_cvt_pk_bf16_f32 v224, v208, v209
    v_cvt_pk_bf16_f32 v225, v210, v211
    v_mfma_f32_16x16x32_bf16 v[64:67], a[176:179], v[228:231], v[64:67]
    s_waitcnt vmcnt(8)
    v_exp_f32 v212, v212
    v_mfma_f32_16x16x32_bf16 v[68:71], a[180:183], v[228:231], v[68:71]
    v_mfma_f32_16x16x32_bf16 v[216:219], a[144:147], a[80:83], v[204:207]
    v_exp_f32 v213, v213
    v_mfma_f32_16x16x32_bf16 v[216:219], a[148:151], a[84:87], v[216:219]
    ds_read_b128 a[144:147], v8 offset:16384
    ds_read_b128 a[148:151], v9 offset:16384
    v_mfma_f32_16x16x32_bf16 v[216:219], a[152:155], a[88:91], v[216:219]
    v_exp_f32 v214, v214
    v_mfma_f32_16x16x32_bf16 v[216:219], a[156:159], a[92:95], v[216:219]
    ds_read_b128 a[152:155], v10 offset:16384
    ds_read_b128 a[156:159], v11 offset:16384
    v_mfma_f32_16x16x32_bf16 v[220:223], a[160:163], a[80:83], v[204:207]
    v_exp_f32 v215, v215
    v_mfma_f32_16x16x32_bf16 v[220:223], a[164:167], a[84:87], v[220:223]
    v_cvt_pk_bf16_f32 v226, v212, v213
    v_cvt_pk_bf16_f32 v227, v214, v215
    v_mfma_f32_16x16x32_bf16 v[220:223], a[168:171], a[88:91], v[220:223]
    ds_read_b128 a[160:163], v8 offset:20480
    ds_read_b128 a[164:167], v9 offset:20480
    v_mfma_f32_16x16x32_bf16 v[220:223], a[172:175], a[92:95], v[220:223]
    v_exp_f32 v216, v216
    v_mfma_f32_16x16x32_bf16 a[128:131], a[184:187], v[224:227], a[128:131]
    v_exp_f32 v217, v217
    v_mfma_f32_16x16x32_bf16 v[152:155], v[224:227], a[188:191], v[152:155]
    ds_read_b128 a[168:171], v10 offset:20480
    ds_read_b128 a[172:175], v11 offset:20480
    v_mfma_f32_16x16x32_bf16 v[156:159], v[224:227], a[192:195], v[156:159]
    v_exp_f32 v218, v218
    v_mfma_f32_16x16x32_bf16 v[160:163], v[224:227], a[196:199], v[160:163]
    v_mfma_f32_16x16x32_bf16 v[164:167], v[224:227], a[200:203], v[164:167]
    v_exp_f32 v219, v219
    v_mfma_f32_16x16x32_bf16 v[240:243], v[224:227], a[204:207], v[240:243]
    v_cvt_pk_bf16_f32 v228, v216, v217
    v_cvt_pk_bf16_f32 v229, v218, v219
    v_mfma_f32_16x16x32_bf16 v[72:75], a[176:179], v[224:227], v[72:75]
    v_exp_f32 v220, v220
    v_mfma_f32_16x16x32_bf16 v[76:79], a[180:183], v[224:227], v[76:79]
    s_waitcnt lgkmcnt(0)
    v_mfma_f32_16x16x32_bf16 v[208:211], a[144:147], a[0:3], v[184:187]
    v_exp_f32 v221, v221
    v_mfma_f32_16x16x32_bf16 v[208:211], a[148:151], a[4:7], v[208:211]
    v_mfma_f32_16x16x32_bf16 v[208:211], a[152:155], a[8:11], v[208:211]
    v_exp_f32 v222, v222
    v_mfma_f32_16x16x32_bf16 v[208:211], a[156:159], a[12:15], v[208:211]
    v_mfma_f32_16x16x32_bf16 v[212:215], a[160:163], a[0:3], v[184:187]
    v_exp_f32 v223, v223
    v_mfma_f32_16x16x32_bf16 v[212:215], a[164:167], a[4:7], v[212:215]
    v_cvt_pk_bf16_f32 v230, v220, v221
    v_cvt_pk_bf16_f32 v231, v222, v223
    v_mfma_f32_16x16x32_bf16 v[212:215], a[168:171], a[8:11], v[212:215]
    s_waitcnt vmcnt(0)
    v_mfma_f32_16x16x32_bf16 v[212:215], a[172:175], a[12:15], v[212:215]
    v_exp_f32 v208, v208
    v_smfmac_f32_16x16x64_bf16 v[252:255], a[240:243], v[224:231], v6
    v_mfma_f32_16x16x32_bf16 v[232:235], v[228:231], a[184:187], v[232:235]
    v_exp_f32 v209, v209
    v_mfma_f32_16x16x32_bf16 v[168:171], v[228:231], a[188:191], v[168:171]
    ds_read_b64_tr_b16 a[184:185], v14 offset:24576
    ds_read_b64_tr_b16 a[186:187], v14 offset:28672
    v_mfma_f32_16x16x32_bf16 v[172:175], v[228:231], a[192:195], v[172:175]
    v_exp_f32 v210, v210
    v_mfma_f32_16x16x32_bf16 v[176:179], v[228:231], a[196:199], v[176:179]
    ds_read_b64_tr_b16 a[188:189], v15 offset:24576
    ds_read_b64_tr_b16 a[190:191], v15 offset:28672
    v_mfma_f32_16x16x32_bf16 v[180:183], v[228:231], a[200:203], v[180:183]
    v_exp_f32 v211, v211
    v_mfma_f32_16x16x32_bf16 v[248:251], v[228:231], a[204:207], v[248:251]
    v_cvt_pk_bf16_f32 v224, v208, v209
    v_cvt_pk_bf16_f32 v225, v210, v211
    v_mfma_f32_16x16x32_bf16 v[80:83], a[176:179], v[228:231], v[80:83]
    v_exp_f32 v212, v212
    v_mfma_f32_16x16x32_bf16 v[84:87], a[180:183], v[228:231], v[84:87]
    ds_read_b64_tr_b16 a[192:193], v16 offset:24576
    ds_read_b64_tr_b16 a[194:195], v16 offset:28672
    v_mfma_f32_16x16x32_bf16 v[216:219], a[144:147], a[16:19], v[188:191]
    v_exp_f32 v213, v213
    v_mfma_f32_16x16x32_bf16 v[216:219], a[148:151], a[20:23], v[216:219]
    ds_read_b64_tr_b16 a[196:197], v17 offset:24576
    ds_read_b64_tr_b16 a[198:199], v17 offset:28672
    v_mfma_f32_16x16x32_bf16 v[216:219], a[152:155], a[24:27], v[216:219]
    v_exp_f32 v214, v214
    v_mfma_f32_16x16x32_bf16 v[216:219], a[156:159], a[28:31], v[216:219]
    ds_read_b64_tr_b16 a[200:201], v18 offset:24576
    ds_read_b64_tr_b16 a[202:203], v18 offset:28672
    v_mfma_f32_16x16x32_bf16 v[220:223], a[160:163], a[16:19], v[188:191]
    v_exp_f32 v215, v215
    v_mfma_f32_16x16x32_bf16 v[220:223], a[164:167], a[20:23], v[220:223]
    v_cvt_pk_bf16_f32 v226, v212, v213
    v_cvt_pk_bf16_f32 v227, v214, v215
    v_mfma_f32_16x16x32_bf16 v[220:223], a[168:171], a[24:27], v[220:223]
    ds_read_b64_tr_b16 a[204:205], v19 offset:24576
    ds_read_b64_tr_b16 a[206:207], v19 offset:28672
    ds_read_b64_tr_b16 a[176:177], v12 offset:24576
    v_mfma_f32_16x16x32_bf16 v[220:223], a[172:175], a[28:31], v[220:223]
    ds_read_b64_tr_b16 a[178:179], v12 offset:28672
    v_exp_f32 v216, v216
    s_waitcnt lgkmcnt(6)
    v_mfma_f32_16x16x32_bf16 a[96:99], a[184:187], v[224:227], a[96:99]
    v_exp_f32 v217, v217
    v_mfma_f32_16x16x32_bf16 v[88:91], v[224:227], a[188:191], v[88:91]
    ds_read_b64_tr_b16 a[180:181], v13 offset:24576
    ds_read_b64_tr_b16 a[182:183], v13 offset:28672
    v_mfma_f32_16x16x32_bf16 v[92:95], v[224:227], a[192:195], v[92:95]
    v_exp_f32 v218, v218
    v_mfma_f32_16x16x32_bf16 v[96:99], v[224:227], a[196:199], v[96:99]
    s_waitcnt lgkmcnt(0)
    ds_write_b128 v1, a[96:99] offset:27904
    v_mfma_f32_16x16x32_bf16 v[100:103], v[224:227], a[200:203], v[100:103]
    v_exp_f32 v219, v219
    v_mfma_f32_16x16x32_bf16 a[100:103], a[204:207], v[224:227], a[100:103]
    ds_write_addtid_b32 v88 offset:0
    v_cvt_pk_bf16_f32 v228, v216, v217
    v_cvt_pk_bf16_f32 v229, v218, v219
    v_mfma_f32_16x16x32_bf16 v[40:43], a[176:179], v[224:227], v[40:43]
    v_exp_f32 v220, v220
    v_mfma_f32_16x16x32_bf16 v[44:47], a[180:183], v[224:227], v[44:47]
    ds_write_addtid_b32 v89 offset:6944
    ds_write_addtid_b32 v90 offset:13952
    ds_write_addtid_b32 v91 offset:20896
    v_mfma_f32_16x16x32_bf16 v[208:211], a[144:147], a[32:35], v[192:195]
    v_exp_f32 v221, v221
    v_mfma_f32_16x16x32_bf16 v[208:211], a[148:151], a[36:39], v[208:211]
    ds_write_addtid_b32 v92 offset:256
    ds_write_addtid_b32 v93 offset:7200
    ds_write_addtid_b32 v94 offset:14208
    v_mfma_f32_16x16x32_bf16 v[208:211], a[152:155], a[40:43], v[208:211]
    v_exp_f32 v222, v222
    v_mfma_f32_16x16x32_bf16 v[208:211], a[156:159], a[44:47], v[208:211]
    ds_write_addtid_b32 v95 offset:21152
    ds_write_addtid_b32 v96 offset:512
    ds_write_addtid_b32 v97 offset:7456
    v_mfma_f32_16x16x32_bf16 v[212:215], a[160:163], a[32:35], v[192:195]
    v_exp_f32 v223, v223
    v_mfma_f32_16x16x32_bf16 v[212:215], a[164:167], a[36:39], v[212:215]
    ds_write_addtid_b32 v98 offset:14464
    v_cvt_pk_bf16_f32 v230, v220, v221
    v_cvt_pk_bf16_f32 v231, v222, v223
    v_mfma_f32_16x16x32_bf16 v[212:215], a[168:171], a[40:43], v[212:215]
    ds_write_addtid_b32 v99 offset:21408
    ds_write_addtid_b32 v100 offset:768
    ds_write_addtid_b32 v101 offset:7712
    v_mfma_f32_16x16x32_bf16 v[212:215], a[172:175], a[44:47], v[212:215]
    v_exp_f32 v208, v208
    v_smfmac_f32_16x16x64_bf16 v[236:239], a[240:243], v[224:231], v6
    ds_write_addtid_b32 v102 offset:14720
    ds_write_addtid_b32 v103 offset:21664
    v_mfma_f32_16x16x32_bf16 a[104:107], a[184:187], v[228:231], a[104:107]
    v_exp_f32 v209, v209
    v_mfma_f32_16x16x32_bf16 v[104:107], v[228:231], a[188:191], v[104:107]
    ds_write_b128 v1, a[100:103] offset:28928
    v_mfma_f32_16x16x32_bf16 v[108:111], v[228:231], a[192:195], v[108:111]
    v_exp_f32 v210, v210
    v_mfma_f32_16x16x32_bf16 v[112:115], v[228:231], a[196:199], v[112:115]
    ds_write_b128 v1, a[104:107] offset:29952
    v_mfma_f32_16x16x32_bf16 v[116:119], v[228:231], a[200:203], v[116:119]
    v_exp_f32 v211, v211
    v_mfma_f32_16x16x32_bf16 a[108:111], a[204:207], v[228:231], a[108:111]
    ds_write_addtid_b32 v104 offset:1024
    v_cvt_pk_bf16_f32 v224, v208, v209
    v_cvt_pk_bf16_f32 v225, v210, v211
    v_mfma_f32_16x16x32_bf16 v[48:51], a[176:179], v[228:231], v[48:51]
L_t7:
    s_cbranch_vccnz L_tr
    v_exp_f32 v212, v212
    v_mfma_f32_16x16x32_bf16 v[52:55], a[180:183], v[228:231], v[52:55]
    ds_write_addtid_b32 v105 offset:7968
    ds_write_addtid_b32 v106 offset:14976
    ds_write_addtid_b32 v107 offset:21920
    ds_write_addtid_b32 v108 offset:1280
    v_mfma_f32_16x16x32_bf16 v[216:219], a[144:147], a[48:51], v[196:199]
    v_exp_f32 v213, v213
    v_mfma_f32_16x16x32_bf16 v[216:219], a[148:151], a[52:55], v[216:219]
    ds_write_addtid_b32 v109 offset:8224
    ds_write_addtid_b32 v110 offset:15232
    ds_write_addtid_b32 v111 offset:22176
    ds_write_addtid_b32 v112 offset:1536
    v_mfma_f32_16x16x32_bf16 v[216:219], a[152:155], a[56:59], v[216:219]
    v_exp_f32 v214, v214
    v_mfma_f32_16x16x32_bf16 v[216:219], a[156:159], a[60:63], v[216:219]
    ds_write_addtid_b32 v113 offset:8480
    ds_write_addtid_b32 v114 offset:15488
    ds_write_addtid_b32 v115 offset:22432
    v_add_f32 v236, v236, v238
    v_add_f32 v237, v237, v239
    v_mfma_f32_16x16x32_bf16 v[220:223], a[160:163], a[48:51], v[196:199]
    v_exp_f32 v215, v215
    v_mfma_f32_16x16x32_bf16 v[220:223], a[164:167], a[52:55], v[220:223]
    ds_write_b64 v2, v[236:237] offset:37120
    v_cvt_pk_bf16_f32 v226, v212, v213
    v_cvt_pk_bf16_f32 v227, v214, v215
    v_mfma_f32_16x16x32_bf16 v[220:223], a[168:171], a[56:59], v[220:223]
    ds_write_addtid_b32 v116 offset:1792
    ds_write_addtid_b32 v117 offset:8736
    ds_write_addtid_b32 v118 offset:15744
    ds_write_addtid_b32 v119 offset:22688
    v_mfma_f32_16x16x32_bf16 v[220:223], a[172:175], a[60:63], v[220:223]
    v_exp_f32 v216, v216
    v_mfma_f32_16x16x32_bf16 a[112:115], a[184:187], v[224:227], a[112:115]
    v_exp_f32 v217, v217
    v_mfma_f32_16x16x32_bf16 v[120:123], v[224:227], a[188:191], v[120:123]
    ds_write_b128 v1, a[108:111] offset:30976
    v_mfma_f32_16x16x32_bf16 v[124:127], v[224:227], a[192:195], v[124:127]
    v_exp_f32 v218, v218
    v_mfma_f32_16x16x32_bf16 v[128:131], v[224:227], a[196:199], v[128:131]
    ds_write_b128 v1, a[112:115] offset:32000
    v_mfma_f32_16x16x32_bf16 v[132:135], v[224:227], a[200:203], v[132:135]
    v_exp_f32 v219, v219
    v_mfma_f32_16x16x32_bf16 a[116:119], a[204:207], v[224:227], a[116:119]
    ds_write_addtid_b32 v120 offset:2048
    v_cvt_pk_bf16_f32 v228, v216, v217
    v_cvt_pk_bf16_f32 v229, v218, v219
    v_mfma_f32_16x16x32_bf16 v[56:59], a[176:179], v[224:227], v[56:59]
    v_exp_f32 v220, v220
    v_mfma_f32_16x16x32_bf16 v[60:63], a[180:183], v[224:227], v[60:63]
    ds_write_addtid_b32 v121 offset:8992
    ds_write_addtid_b32 v122 offset:16000
    ds_write_addtid_b32 v123 offset:22944
    v_mfma_f32_16x16x32_bf16 v[208:211], a[144:147], a[64:67], v[200:203]
    v_exp_f32 v221, v221
    v_mfma_f32_16x16x32_bf16 v[208:211], a[148:151], a[68:71], v[208:211]
    ds_write_addtid_b32 v124 offset:2304
    ds_write_addtid_b32 v125 offset:9248
    ds_write_addtid_b32 v126 offset:16256
    v_mfma_f32_16x16x32_bf16 v[208:211], a[152:155], a[72:75], v[208:211]
    v_exp_f32 v222, v222
    v_mfma_f32_16x16x32_bf16 v[208:211], a[156:159], a[76:79], v[208:211]
    ds_write_addtid_b32 v127 offset:23200
    ds_write_addtid_b32 v128 offset:2560
    ds_write_addtid_b32 v129 offset:9504
    v_mfma_f32_16x16x32_bf16 v[212:215], a[160:163], a[64:67], v[200:203]
    v_exp_f32 v223, v223
    v_mfma_f32_16x16x32_bf16 v[212:215], a[164:167], a[68:71], v[212:215]
    ds_write_addtid_b32 v130 offset:16512
    v_cvt_pk_bf16_f32 v230, v220, v221
    v_cvt_pk_bf16_f32 v231, v222, v223
    v_mfma_f32_16x16x32_bf16 v[212:215], a[168:171], a[72:75], v[212:215]
    ds_write_addtid_b32 v131 offset:23456
    ds_write_addtid_b32 v132 offset:2816
    ds_write_addtid_b32 v133 offset:9760
    v_mfma_f32_16x16x32_bf16 v[212:215], a[172:175], a[76:79], v[212:215]
    v_exp_f32 v208, v208
    v_smfmac_f32_16x16x64_bf16 v[244:247], a[240:243], v[224:231], v6
    ds_write_addtid_b32 v134 offset:16768
    ds_write_addtid_b32 v135 offset:23712
    v_mfma_f32_16x16x32_bf16 a[120:123], a[184:187], v[228:231], a[120:123]
    v_exp_f32 v209, v209
    v_mfma_f32_16x16x32_bf16 v[136:139], v[228:231], a[188:191], v[136:139]
    ds_write_b128 v1, a[116:119] offset:33024
    v_mfma_f32_16x16x32_bf16 v[140:143], v[228:231], a[192:195], v[140:143]
    v_exp_f32 v210, v210
    v_mfma_f32_16x16x32_bf16 v[144:147], v[228:231], a[196:199], v[144:147]
    ds_write_b128 v1, a[120:123] offset:34048
    v_mfma_f32_16x16x32_bf16 v[148:151], v[228:231], a[200:203], v[148:151]
    v_exp_f32 v211, v211
    v_mfma_f32_16x16x32_bf16 a[124:127], a[204:207], v[228:231], a[124:127]
    ds_write_addtid_b32 v136 offset:3072
    v_cvt_pk_bf16_f32 v224, v208, v209
    v_cvt_pk_bf16_f32 v225, v210, v211
    v_mfma_f32_16x16x32_bf16 v[64:67], a[176:179], v[228:231], v[64:67]
    v_exp_f32 v212, v212
    v_mfma_f32_16x16x32_bf16 v[68:71], a[180:183], v[228:231], v[68:71]
    ds_write_addtid_b32 v137 offset:10016
    ds_write_addtid_b32 v138 offset:17024
    ds_write_addtid_b32 v139 offset:23968
    ds_write_addtid_b32 v140 offset:3328
    v_mfma_f32_16x16x32_bf16 v[216:219], a[144:147], a[80:83], v[204:207]
    v_exp_f32 v213, v213
    v_mfma_f32_16x16x32_bf16 v[216:219], a[148:151], a[84:87], v[216:219]
    ds_write_addtid_b32 v141 offset:10272
    ds_write_addtid_b32 v142 offset:17280
    ds_write_addtid_b32 v143 offset:24224
    ds_write_addtid_b32 v144 offset:3584
    v_mfma_f32_16x16x32_bf16 v[216:219], a[152:155], a[88:91], v[216:219]
    v_exp_f32 v214, v214
    v_mfma_f32_16x16x32_bf16 v[216:219], a[156:159], a[92:95], v[216:219]
    ds_write_addtid_b32 v145 offset:10528
    ds_write_addtid_b32 v146 offset:17536
    ds_write_addtid_b32 v147 offset:24480
    v_add_f32 v244, v244, v246
    v_add_f32 v245, v245, v247
    v_mfma_f32_16x16x32_bf16 v[220:223], a[160:163], a[80:83], v[204:207]
    v_exp_f32 v215, v215
    v_mfma_f32_16x16x32_bf16 v[220:223], a[164:167], a[84:87], v[220:223]
    ds_write_b64 v2, v[244:245] offset:37128
    v_cvt_pk_bf16_f32 v226, v212, v213
    v_cvt_pk_bf16_f32 v227, v214, v215
    v_mfma_f32_16x16x32_bf16 v[220:223], a[168:171], a[88:91], v[220:223]
    ds_write_addtid_b32 v148 offset:3840
    ds_write_addtid_b32 v149 offset:10784
    ds_write_addtid_b32 v150 offset:17792
    ds_write_addtid_b32 v151 offset:24736
    v_mfma_f32_16x16x32_bf16 v[220:223], a[172:175], a[92:95], v[220:223]
    v_exp_f32 v216, v216
    v_mfma_f32_16x16x32_bf16 a[128:131], a[184:187], v[224:227], a[128:131]
    v_exp_f32 v217, v217
    v_mfma_f32_16x16x32_bf16 v[152:155], v[224:227], a[188:191], v[152:155]
    ds_write_b128 v1, a[124:127] offset:35072
    v_mfma_f32_16x16x32_bf16 v[156:159], v[224:227], a[192:195], v[156:159]
    v_exp_f32 v218, v218
    v_mfma_f32_16x16x32_bf16 v[160:163], v[224:227], a[196:199], v[160:163]
    ds_write_b128 v1, a[128:131] offset:36096
    v_mfma_f32_16x16x32_bf16 v[164:167], v[224:227], a[200:203], v[164:167]
    v_exp_f32 v219, v219
    v_mfma_f32_16x16x32_bf16 v[240:243], v[224:227], a[204:207], v[240:243]
    v_cvt_pk_bf16_f32 v228, v216, v217
    v_cvt_pk_bf16_f32 v229, v218, v219
    s_waitcnt lgkmcnt(1)
    s_barrier
    v_mfma_f32_16x16x32_bf16 v[72:75], a[176:179], v[224:227], v[72:75]
    ds_read_b128 v[88:91], v30 offset:27904
    ds_read_b128 v[92:95], v31
    v_exp_f32 v220, v220
    v_mfma_f32_16x16x32_bf16 v[76:79], a[180:183], v[224:227], v[76:79]
    ds_read_b128 v[96:99], v32 offset:256
    ds_read_b128 v[100:103], v32 offset:512
    ds_read_b128 v[104:107], v33 offset:768
    ds_read_b128 v[108:111], v38 offset:28928
L_epi:
    ds_read_b128 v[184:187], v35 offset:37120
    v_exp_f32 v221, v221
    ds_read_b128 v[192:195], v36 offset:37120
    v_exp_f32 v222, v222
    ds_read_b128 v[200:203], v37 offset:37120
    v_exp_f32 v223, v223
    v_cvt_pk_bf16_f32 v230, v220, v221
    v_cvt_pk_bf16_f32 v231, v222, v223
    ds_write_addtid_b32 v152 offset:4096
    ds_write_addtid_b32 v153 offset:11040
    ds_write_addtid_b32 v154 offset:18048
    ds_write_addtid_b32 v155 offset:24992
    v_smfmac_f32_16x16x64_bf16 v[252:255], a[240:243], v[224:231], v6
    v_mfma_f32_16x16x32_bf16 v[232:235], v[228:231], a[184:187], v[232:235]
    v_mfma_f32_16x16x32_bf16 v[168:171], v[228:231], a[188:191], v[168:171]
    ds_write_addtid_b32 v156 offset:4352
    ds_write_addtid_b32 v157 offset:11296
    ds_write_addtid_b32 v158 offset:18304
    ds_write_addtid_b32 v159 offset:25248
    v_mfma_f32_16x16x32_bf16 v[172:175], v[228:231], a[192:195], v[172:175]
    v_mfma_f32_16x16x32_bf16 v[176:179], v[228:231], a[196:199], v[176:179]
    v_mfma_f32_16x16x32_bf16 v[180:183], v[228:231], a[200:203], v[180:183]
    ds_write_addtid_b32 v160 offset:4608
    ds_write_addtid_b32 v161 offset:11552
    ds_write_addtid_b32 v162 offset:18560
    ds_write_addtid_b32 v163 offset:25504
    v_mfma_f32_16x16x32_bf16 v[248:251], v[228:231], a[204:207], v[248:251]
    v_add_f32 v252, v252, v254
    v_add_f32 v253, v253, v255
    ds_write_b64 v2, v[252:253] offset:37136
    v_mfma_f32_16x16x32_bf16 v[80:83], a[176:179], v[228:231], v[80:83]
    v_mfma_f32_16x16x32_bf16 v[84:87], a[180:183], v[228:231], v[84:87]
    ds_write_addtid_b32 v164 offset:4864
    ds_write_addtid_b32 v165 offset:11808
    ds_write_addtid_b32 v166 offset:18816
    ds_write_addtid_b32 v167 offset:25760
    ds_read_b128 v[112:115], v30 offset:29952
    s_waitcnt lgkmcnt(15)
    v_pk_add_f32 v[40:41], v[40:41], v[88:89]
    v_pk_add_f32 v[42:43], v[42:43], v[90:91]
    ds_read_b128 v[116:119], v31 offset:1024
    v_pk_add_f32 v[44:45], v[44:45], v[92:93]
    v_pk_add_f32 v[46:47], v[46:47], v[94:95]
    ds_read_b128 v[120:123], v32 offset:1280
    v_pk_add_f32 v[40:41], v[40:41], v[96:97]
    v_pk_add_f32 v[42:43], v[42:43], v[98:99]
    ds_read_b128 v[124:127], v32 offset:1536
    v_pk_add_f32 v[44:45], v[44:45], v[100:101]
    v_pk_add_f32 v[46:47], v[46:47], v[102:103]
    ds_read_b128 v[128:131], v33 offset:1792
    v_pk_add_f32 v[40:41], v[40:41], v[104:105]
    v_pk_add_f32 v[42:43], v[42:43], v[106:107]
    ds_read_b128 v[132:135], v38 offset:30976
    v_pk_add_f32 v[44:45], v[44:45], v[108:109]
    v_pk_add_f32 v[46:47], v[46:47], v[110:111]
    ds_write_addtid_b32 v240 offset:5120
    ds_write_addtid_b32 v241 offset:12064
    ds_write_addtid_b32 v242 offset:19072
    ds_write_addtid_b32 v243 offset:26016
    v_pk_add_f32 v[192:193], v[192:193], v[200:201]
    v_pk_add_f32 v[194:195], v[194:195], v[202:203]
    v_pk_add_f32 v[184:185], v[184:185], v[236:237]
    v_pk_add_f32 v[186:187], v[186:187], v[244:245]
    v_pk_add_f32 v[184:185], v[184:185], v[192:193]
    v_pk_add_f32 v[186:187], v[186:187], v[194:195]
    v_pk_add_f32 v[192:193], v[184:185], v[186:187]
    v_rcp_f32 v184, v184
    ds_write_addtid_b32 v232 offset:5376
    ds_write_addtid_b32 v233 offset:12320
    ds_write_addtid_b32 v234 offset:19328
    ds_write_addtid_b32 v235 offset:26272
    v_pk_mul_f32 v[40:41], v[40:41], v[184:185] op_sel_hi:[1,0]
    v_pk_mul_f32 v[42:43], v[42:43], v[184:185] op_sel_hi:[1,0]
    v_pk_mul_f32 v[44:45], v[44:45], v[184:185] op_sel_hi:[1,0]
    v_pk_mul_f32 v[46:47], v[46:47], v[184:185] op_sel_hi:[1,0]
    v_cvt_pk_bf16_f32 v232, v40, v41
    v_cvt_pk_bf16_f32 v234, v44, v45
    v_cvt_pk_bf16_f32 v233, v42, v43
    v_cvt_pk_bf16_f32 v235, v46, v47
    v_rcp_f32 v185, v185
    v_permlane16_swap_b32 v232, v234
    v_permlane16_swap_b32 v233, v235
    buffer_store_dwordx4 v[232:235], v3, s[28:31], 0 offen sc0 sc1
    ds_write_addtid_b32 v168 offset:5632
    ds_write_addtid_b32 v169 offset:12576
    ds_write_addtid_b32 v170 offset:19584
    ds_write_addtid_b32 v171 offset:26528
    ds_read_b128 v[88:91], v30 offset:32000
    s_waitcnt lgkmcnt(15)
    v_pk_add_f32 v[48:49], v[48:49], v[112:113]
    v_pk_add_f32 v[50:51], v[50:51], v[114:115]
    ds_read_b128 v[92:95], v31 offset:2048
    v_pk_add_f32 v[52:53], v[52:53], v[116:117]
    v_pk_add_f32 v[54:55], v[54:55], v[118:119]
    ds_read_b128 v[96:99], v32 offset:2304
    v_pk_add_f32 v[48:49], v[48:49], v[120:121]
    v_pk_add_f32 v[50:51], v[50:51], v[122:123]
    ds_read_b128 v[100:103], v32 offset:2560
    v_pk_add_f32 v[52:53], v[52:53], v[124:125]
    v_pk_add_f32 v[54:55], v[54:55], v[126:127]
    ds_read_b128 v[104:107], v33 offset:2816
    s_waitcnt lgkmcnt(15)
    v_pk_add_f32 v[48:49], v[48:49], v[128:129]
    v_pk_add_f32 v[50:51], v[50:51], v[130:131]
    ds_read_b128 v[108:111], v38 offset:33024
    v_pk_add_f32 v[52:53], v[52:53], v[132:133]
    v_pk_add_f32 v[54:55], v[54:55], v[134:135]
    ds_write_addtid_b32 v172 offset:5888
    ds_write_addtid_b32 v173 offset:12832
    ds_write_addtid_b32 v174 offset:19840
    ds_write_addtid_b32 v175 offset:26784
    v_pk_mul_f32 v[48:49], v[48:49], v[184:185] op_sel:[0,1]
    v_pk_mul_f32 v[50:51], v[50:51], v[184:185] op_sel:[0,1]
    v_pk_mul_f32 v[52:53], v[52:53], v[184:185] op_sel:[0,1]
    v_pk_mul_f32 v[54:55], v[54:55], v[184:185] op_sel:[0,1]
    v_cvt_pk_bf16_f32 v236, v48, v49
    v_cvt_pk_bf16_f32 v238, v52, v53
    v_cvt_pk_bf16_f32 v237, v50, v51
    v_cvt_pk_bf16_f32 v239, v54, v55
    v_rcp_f32 v186, v186
    v_permlane16_swap_b32 v236, v238
    v_permlane16_swap_b32 v237, v239
    buffer_store_dwordx4 v[236:239], v3, s[28:31], s53 offen sc0 sc1
    ds_write_addtid_b32 v176 offset:6144
    ds_write_addtid_b32 v177 offset:13088
    ds_write_addtid_b32 v178 offset:20096
    ds_write_addtid_b32 v179 offset:27040
    ds_read_b128 v[112:115], v30 offset:34048
    s_waitcnt lgkmcnt(14)
    v_pk_add_f32 v[56:57], v[56:57], v[88:89]
    v_pk_add_f32 v[58:59], v[58:59], v[90:91]
    ds_read_b128 v[116:119], v31 offset:3072
    s_waitcnt lgkmcnt(14)
    v_pk_add_f32 v[60:61], v[60:61], v[92:93]
    v_pk_add_f32 v[62:63], v[62:63], v[94:95]
    ds_read_b128 v[120:123], v32 offset:3328
    s_waitcnt lgkmcnt(14)
    v_pk_add_f32 v[56:57], v[56:57], v[96:97]
    v_pk_add_f32 v[58:59], v[58:59], v[98:99]
    ds_read_b128 v[124:127], v32 offset:3584
    s_waitcnt lgkmcnt(14)
    v_pk_add_f32 v[60:61], v[60:61], v[100:101]
    v_pk_add_f32 v[62:63], v[62:63], v[102:103]
    ds_read_b128 v[128:131], v33 offset:3840
    s_waitcnt lgkmcnt(14)
    v_pk_add_f32 v[56:57], v[56:57], v[104:105]
    v_pk_add_f32 v[58:59], v[58:59], v[106:107]
    ds_read_b128 v[132:135], v38 offset:35072
    s_waitcnt lgkmcnt(14)
    v_pk_add_f32 v[60:61], v[60:61], v[108:109]
    v_pk_add_f32 v[62:63], v[62:63], v[110:111]
    ds_write_addtid_b32 v180 offset:6400
L_tE:
    s_cbranch_vccnz L_tr
    ds_write_addtid_b32 v181 offset:13344
    ds_write_addtid_b32 v182 offset:20352
    ds_write_addtid_b32 v183 offset:27296
    v_pk_mul_f32 v[56:57], v[56:57], v[186:187] op_sel_hi:[1,0]
    v_pk_mul_f32 v[58:59], v[58:59], v[186:187] op_sel_hi:[1,0]
    v_pk_mul_f32 v[60:61], v[60:61], v[186:187] op_sel_hi:[1,0]
    v_pk_mul_f32 v[62:63], v[62:63], v[186:187] op_sel_hi:[1,0]
    v_cvt_pk_bf16_f32 v240, v56, v57
    v_cvt_pk_bf16_f32 v242, v60, v61
    v_cvt_pk_bf16_f32 v241, v58, v59
    v_cvt_pk_bf16_f32 v243, v62, v63
    v_rcp_f32 v187, v187
    v_permlane16_swap_b32 v240, v242
    v_permlane16_swap_b32 v241, v243
    buffer_store_dwordx4 v[240:243], v3, s[28:31], s54 offen sc0 sc1
    ds_write_addtid_b32 v248 offset:6656
    ds_write_addtid_b32 v249 offset:13600
    ds_write_addtid_b32 v250 offset:20608
    ds_write_addtid_b32 v251 offset:27552
    s_waitcnt lgkmcnt(13)
    v_pk_add_f32 v[64:65], v[64:65], v[112:113]
    v_pk_add_f32 v[66:67], v[66:67], v[114:115]
    s_waitcnt lgkmcnt(12)
    v_pk_add_f32 v[68:69], v[68:69], v[116:117]
    v_pk_add_f32 v[70:71], v[70:71], v[118:119]
    s_waitcnt lgkmcnt(11)
    v_pk_add_f32 v[64:65], v[64:65], v[120:121]
    v_pk_add_f32 v[66:67], v[66:67], v[122:123]
    s_waitcnt lgkmcnt(10)
    v_pk_add_f32 v[68:69], v[68:69], v[124:125]
    v_pk_add_f32 v[70:71], v[70:71], v[126:127]
    s_waitcnt lgkmcnt(9)
    v_pk_add_f32 v[64:65], v[64:65], v[128:129]
    v_pk_add_f32 v[66:67], v[66:67], v[130:131]
    s_waitcnt lgkmcnt(8)
    v_pk_add_f32 v[68:69], v[68:69], v[132:133]
    v_pk_add_f32 v[70:71], v[70:71], v[134:135]
    s_waitcnt lgkmcnt(0)
    s_barrier
    ds_read_b128 v[136:139], v30 offset:36096
    v_pk_mul_f32 v[64:65], v[64:65], v[186:187] op_sel:[0,1]
    ds_read_b128 v[140:143], v31 offset:4096
    v_pk_mul_f32 v[66:67], v[66:67], v[186:187] op_sel:[0,1]
    ds_read_b128 v[144:147], v32 offset:4352
    v_pk_mul_f32 v[68:69], v[68:69], v[186:187] op_sel:[0,1]
    ds_read_b128 v[148:151], v32 offset:4608
    v_pk_mul_f32 v[70:71], v[70:71], v[186:187] op_sel:[0,1]
    ds_read_b128 v[152:155], v33 offset:4864
    v_cvt_pk_bf16_f32 v244, v64, v65
    v_cvt_pk_bf16_f32 v246, v68, v69
    ds_read_b128 v[156:159], v33 offset:5120
    v_cvt_pk_bf16_f32 v245, v66, v67
    ds_read_b64 v[188:189], v35 offset:37136
    v_cvt_pk_bf16_f32 v247, v70, v71
    ds_read_b64 v[196:197], v36 offset:37136
    v_permlane16_swap_b32 v244, v246
    ds_read_b64 v[204:205], v37 offset:37136
    v_permlane16_swap_b32 v245, v247
    buffer_store_dwordx4 v[244:247], v3, s[28:31], s55 offen sc0 sc1
    s_waitcnt lgkmcnt(0)
    v_pk_add_f32 v[196:197], v[196:197], v[204:205]
    v_pk_add_f32 v[188:189], v[188:189], v[252:253]
    v_pk_add_f32 v[188:189], v[188:189], v[196:197]
    v_pk_add_f32 v[192:193], v[192:193], v[188:189]
    v_rcp_f32 v188, v188
    ds_read_b128 v[160:163], v31 offset:5376
    v_pk_add_f32 v[72:73], v[72:73], v[136:137]
    v_pk_add_f32 v[74:75], v[74:75], v[138:139]
    ds_read_b128 v[164:167], v31 offset:5632
    v_pk_add_f32 v[76:77], v[76:77], v[140:141]
    v_pk_add_f32 v[78:79], v[78:79], v[142:143]
    ds_read_b128 v[168:171], v32 offset:5888
    v_pk_add_f32 v[72:73], v[72:73], v[144:145]
    v_pk_add_f32 v[74:75], v[74:75], v[146:147]
    ds_read_b128 v[172:175], v32 offset:6144
    v_pk_add_f32 v[76:77], v[76:77], v[148:149]
    v_pk_add_f32 v[78:79], v[78:79], v[150:151]
    ds_read_b128 v[176:179], v33 offset:6400
    v_pk_add_f32 v[72:73], v[72:73], v[152:153]
    v_pk_add_f32 v[74:75], v[74:75], v[154:155]
    ds_read_b128 v[180:183], v33 offset:6656
    v_pk_add_f32 v[76:77], v[76:77], v[156:157]
    v_pk_add_f32 v[78:79], v[78:79], v[158:159]
    v_pk_mul_f32 v[72:73], v[72:73], v[188:189] op_sel_hi:[1,0]
    v_pk_mul_f32 v[74:75], v[74:75], v[188:189] op_sel_hi:[1,0]
    v_pk_mul_f32 v[76:77], v[76:77], v[188:189] op_sel_hi:[1,0]
    v_pk_mul_f32 v[78:79], v[78:79], v[188:189] op_sel_hi:[1,0]
    v_cvt_pk_bf16_f32 v248, v72, v73
    v_cvt_pk_bf16_f32 v250, v76, v77
    v_cvt_pk_bf16_f32 v249, v74, v75
    v_cvt_pk_bf16_f32 v251, v78, v79
    v_rcp_f32 v189, v189
    v_permlane16_swap_b32 v248, v250
    v_permlane16_swap_b32 v249, v251
    buffer_store_dwordx4 v[248:251], v3, s[28:31], s56 offen sc0 sc1
    s_waitcnt lgkmcnt(5)
    v_pk_add_f32 v[80:81], v[80:81], v[160:161]
    v_pk_add_f32 v[82:83], v[82:83], v[162:163]
    s_waitcnt lgkmcnt(4)
    v_pk_add_f32 v[84:85], v[84:85], v[164:165]
    v_pk_add_f32 v[86:87], v[86:87], v[166:167]
    s_waitcnt lgkmcnt(3)
    v_pk_add_f32 v[80:81], v[80:81], v[168:169]
    v_pk_add_f32 v[82:83], v[82:83], v[170:171]
    s_waitcnt lgkmcnt(2)
    v_pk_add_f32 v[84:85], v[84:85], v[172:173]
    v_pk_add_f32 v[86:87], v[86:87], v[174:175]
    s_waitcnt lgkmcnt(1)
    v_pk_add_f32 v[80:81], v[80:81], v[176:177]
    v_pk_add_f32 v[82:83], v[82:83], v[178:179]
    s_waitcnt lgkmcnt(0)
    v_pk_add_f32 v[84:85], v[84:85], v[180:181]
    v_pk_add_f32 v[86:87], v[86:87], v[182:183]
    v_pk_mul_f32 v[80:81], v[80:81], v[188:189] op_sel:[0,1]
    v_pk_mul_f32 v[82:83], v[82:83], v[188:189] op_sel:[0,1]
    v_pk_mul_f32 v[84:85], v[84:85], v[188:189] op_sel:[0,1]
    v_pk_mul_f32 v[86:87], v[86:87], v[188:189] op_sel:[0,1]
    v_cvt_pk_bf16_f32 v252, v80, v81
    v_cvt_pk_bf16_f32 v254, v84, v85
    v_cvt_pk_bf16_f32 v253, v82, v83
    v_cvt_pk_bf16_f32 v255, v86, v87
    v_permlane16_swap_b32 v252, v254
    s_nop 0
    v_permlane16_swap_b32 v253, v255
    buffer_store_dwordx4 v[252:255], v3, s[28:31], s57 offen sc0 sc1
    v_add_f32 v192, v192, v193
    v_cmp_nge_f32 vcc, s35, v192
    s_nop 3
    s_cbranch_vccnz L_fallback
L_cont:
L_end:
    s_endpgm
L_fallback:
    s_mov_b64 vcc, 0
    s_cmp_lg_u32 s34, 0
    s_cbranch_scc1 L_cont
    s_mov_b32 s34, 1
    s_waitcnt vmcnt(0) lgkmcnt(0)
    v_mov_b32 v32, 0x7f800000
    v_mov_b32 v33, 0x7f800000
    v_lshlrev_b32 v34, 3, v0
    v_add_u32 v34, 0x27800, v34
    v_add_u32 v35, 0x27800, v26
    ds_write_b64 v34, v[32:33]
    s_waitcnt vmcnt(0) lgkmcnt(0)
    s_barrier
    s_branch L_again
L_fbmax:
    s_waitcnt vmcnt(0) lgkmcnt(0)
    s_mov_b32 s38, 0x1e000
    v_add_u32 v35, 0x27800, v26
    ds_read_b128 a[0:3], v80
    ds_read_b128 a[4:7], v81
    ds_read_b128 a[8:11], v82
    ds_read_b128 a[12:15], v83
    ds_read_b128 a[16:19], v80 offset:4096
    ds_read_b128 a[20:23], v81 offset:4096
    ds_read_b128 a[24:27], v82 offset:4096
    ds_read_b128 a[28:31], v83 offset:4096
    ds_read_b128 a[32:35], v80 offset:40960
    ds_read_b128 a[36:39], v81 offset:40960
    ds_read_b128 a[40:43], v82 offset:40960
    ds_read_b128 a[44:47], v83 offset:40960
    ds_read_b128 a[48:51], v80 offset:45056
    ds_read_b128 a[52:55], v81 offset:45056
    ds_read_b128 a[56:59], v82 offset:45056
    ds_read_b128 a[60:63], v83 offset:45056
    ds_read_b128 a[64:67], v84
    ds_read_b128 a[68:71], v85
    ds_read_b128 a[72:75], v86
    ds_read_b128 a[76:79], v87
    ds_read_b128 a[80:83], v84 offset:4096
    ds_read_b128 a[84:87], v85 offset:4096
    ds_read_b128 a[88:91], v86 offset:4096
    ds_read_b128 a[92:95], v87 offset:4096
    v_mov_b32 v216, 0x7f800000
    v_mov_b32 v217, 0x7f800000
    v_mov_b32 v218, 0x7f800000
    v_mov_b32 v219, 0x7f800000
    v_mov_b32 v220, 0x7f800000
    v_mov_b32 v221, 0x7f800000
L_fb_loop:
    s_add_u32 s40, s38, s44
    s_and_b32 s40, s40, 0x1ffff
    s_add_u32 s39, s40, 0x1000
    s_mov_b32 m0, s33
    s_nop 0
    buffer_load_dwordx4 v20, s[16:19], s40 offen nt lds
    buffer_load_dwordx4 v21, s[16:19], s40 offen offset:1024 nt lds
    buffer_load_dwordx4 v22, s[16:19], s40 offen offset:2048 nt lds
    buffer_load_dwordx4 v23, s[16:19], s40 offen offset:3072 nt lds
    s_add_u32 m0, s33, 0x1000
    s_nop 0
    buffer_load_dwordx4 v20, s[16:19], s39 offen nt lds
    buffer_load_dwordx4 v21, s[16:19], s39 offen offset:1024 nt lds
    buffer_load_dwordx4 v22, s[16:19], s39 offen offset:2048 nt lds
    buffer_load_dwordx4 v23, s[16:19], s39 offen offset:3072 nt lds
    s_waitcnt vmcnt(4)
    ds_read_b128 a[144:147], v8
    ds_read_b128 a[148:151], v9
    ds_read_b128 a[152:155], v10
    ds_read_b128 a[156:159], v11
    s_waitcnt vmcnt(0)
    ds_read_b128 a[160:163], v8 offset:4096
    ds_read_b128 a[164:167], v9 offset:4096
    ds_read_b128 a[168:171], v10 offset:4096
    ds_read_b128 a[172:175], v11 offset:4096
    s_waitcnt lgkmcnt(7)
    v_mfma_f32_16x16x32_bf16 v[184:187], a[144:147], a[0:3], 0
    s_waitcnt lgkmcnt(6)
    v_mfma_f32_16x16x32_bf16 v[184:187], a[148:151], a[4:7], v[184:187]
    s_waitcnt lgkmcnt(5)
    v_mfma_f32_16x16x32_bf16 v[184:187], a[152:155], a[8:11], v[184:187]
    s_waitcnt lgkmcnt(4)
    v_mfma_f32_16x16x32_bf16 v[184:187], a[156:159], a[12:15], v[184:187]
    v_mfma_f32_16x16x32_bf16 v[188:191], a[144:147], a[16:19], 0
    v_mfma_f32_16x16x32_bf16 v[188:191], a[148:151], a[20:23], v[188:191]
    v_mfma_f32_16x16x32_bf16 v[188:191], a[152:155], a[24:27], v[188:191]
    v_mfma_f32_16x16x32_bf16 v[188:191], a[156:159], a[28:31], v[188:191]
    v_mfma_f32_16x16x32_bf16 v[192:195], a[144:147], a[32:35], 0
    v_mfma_f32_16x16x32_bf16 v[192:195], a[148:151], a[36:39], v[192:195]
    v_mfma_f32_16x16x32_bf16 v[192:195], a[152:155], a[40:43], v[192:195]
    v_mfma_f32_16x16x32_bf16 v[192:195], a[156:159], a[44:47], v[192:195]
    v_mfma_f32_16x16x32_bf16 v[196:199], a[144:147], a[48:51], 0
    v_mfma_f32_16x16x32_bf16 v[196:199], a[148:151], a[52:55], v[196:199]
    v_mfma_f32_16x16x32_bf16 v[196:199], a[152:155], a[56:59], v[196:199]
    v_mfma_f32_16x16x32_bf16 v[196:199], a[156:159], a[60:63], v[196:199]
    v_mfma_f32_16x16x32_bf16 v[200:203], a[144:147], a[64:67], 0
    v_mfma_f32_16x16x32_bf16 v[200:203], a[148:151], a[68:71], v[200:203]
    v_mfma_f32_16x16x32_bf16 v[200:203], a[152:155], a[72:75], v[200:203]
    v_mfma_f32_16x16x32_bf16 v[200:203], a[156:159], a[76:79], v[200:203]
    v_mfma_f32_16x16x32_bf16 v[204:207], a[144:147], a[80:83], 0
    v_mfma_f32_16x16x32_bf16 v[204:207], a[148:151], a[84:87], v[204:207]
    v_mfma_f32_16x16x32_bf16 v[204:207], a[152:155], a[88:91], v[204:207]
    v_mfma_f32_16x16x32_bf16 v[204:207], a[156:159], a[92:95], v[204:207]
    v_min3_f32 v216, -v184, -v185, v216
    v_min3_f32 v216, -v186, -v187, v216
    v_min3_f32 v217, -v188, -v189, v217
    v_min3_f32 v217, -v190, -v191, v217
    v_min3_f32 v218, -v192, -v193, v218
    v_min3_f32 v218, -v194, -v195, v218
    v_min3_f32 v219, -v196, -v197, v219
    v_min3_f32 v219, -v198, -v199, v219
    v_min3_f32 v220, -v200, -v201, v220
    v_min3_f32 v220, -v202, -v203, v220
    v_min3_f32 v221, -v204, -v205, v221
    v_min3_f32 v221, -v206, -v207, v221
    s_waitcnt lgkmcnt(3)
    v_mfma_f32_16x16x32_bf16 v[184:187], a[160:163], a[0:3], 0
    s_waitcnt lgkmcnt(2)
    v_mfma_f32_16x16x32_bf16 v[184:187], a[164:167], a[4:7], v[184:187]
    s_waitcnt lgkmcnt(1)
    v_mfma_f32_16x16x32_bf16 v[184:187], a[168:171], a[8:11], v[184:187]
    s_waitcnt lgkmcnt(0)
    v_mfma_f32_16x16x32_bf16 v[184:187], a[172:175], a[12:15], v[184:187]
    v_mfma_f32_16x16x32_bf16 v[188:191], a[160:163], a[16:19], 0
    v_mfma_f32_16x16x32_bf16 v[188:191], a[164:167], a[20:23], v[188:191]
    v_mfma_f32_16x16x32_bf16 v[188:191], a[168:171], a[24:27], v[188:191]
    v_mfma_f32_16x16x32_bf16 v[188:191], a[172:175], a[28:31], v[188:191]
    v_mfma_f32_16x16x32_bf16 v[192:195], a[160:163], a[32:35], 0
    v_mfma_f32_16x16x32_bf16 v[192:195], a[164:167], a[36:39], v[192:195]
    v_mfma_f32_16x16x32_bf16 v[192:195], a[168:171], a[40:43], v[192:195]
    v_mfma_f32_16x16x32_bf16 v[192:195], a[172:175], a[44:47], v[192:195]
    v_mfma_f32_16x16x32_bf16 v[196:199], a[160:163], a[48:51], 0
    v_mfma_f32_16x16x32_bf16 v[196:199], a[164:167], a[52:55], v[196:199]
    v_mfma_f32_16x16x32_bf16 v[196:199], a[168:171], a[56:59], v[196:199]
    v_mfma_f32_16x16x32_bf16 v[196:199], a[172:175], a[60:63], v[196:199]
    v_mfma_f32_16x16x32_bf16 v[200:203], a[160:163], a[64:67], 0
    v_mfma_f32_16x16x32_bf16 v[200:203], a[164:167], a[68:71], v[200:203]
    v_mfma_f32_16x16x32_bf16 v[200:203], a[168:171], a[72:75], v[200:203]
    v_mfma_f32_16x16x32_bf16 v[200:203], a[172:175], a[76:79], v[200:203]
    v_mfma_f32_16x16x32_bf16 v[204:207], a[160:163], a[80:83], 0
    v_mfma_f32_16x16x32_bf16 v[204:207], a[164:167], a[84:87], v[204:207]
    v_mfma_f32_16x16x32_bf16 v[204:207], a[168:171], a[88:91], v[204:207]
    v_mfma_f32_16x16x32_bf16 v[204:207], a[172:175], a[92:95], v[204:207]
    v_min3_f32 v216, -v184, -v185, v216
    v_min3_f32 v216, -v186, -v187, v216
    v_min3_f32 v217, -v188, -v189, v217
    v_min3_f32 v217, -v190, -v191, v217
    v_min3_f32 v218, -v192, -v193, v218
    v_min3_f32 v218, -v194, -v195, v218
    v_min3_f32 v219, -v196, -v197, v219
    v_min3_f32 v219, -v198, -v199, v219
    v_min3_f32 v220, -v200, -v201, v220
    v_min3_f32 v220, -v202, -v203, v220
    v_min3_f32 v221, -v204, -v205, v221
    v_min3_f32 v221, -v206, -v207, v221
    s_sub_u32 s38, s38, 0x2000
    s_cbranch_scc0 L_fb_loop
    ds_min_f32 v35, v216
    ds_min_f32 v35, v217 offset:4
    ds_min_f32 v35, v218 offset:8
    ds_min_f32 v35, v219 offset:12
    ds_min_f32 v35, v220 offset:16
    ds_min_f32 v35, v221 offset:20
    s_waitcnt vmcnt(0) lgkmcnt(0)
    s_barrier
    ds_read_b128 v[30:33], v35
    ds_read_b64 v[36:37], v35 offset:16
    s_waitcnt lgkmcnt(1)
    v_mov_b32 v184, v30
    v_mov_b32 v185, v30
    v_mov_b32 v186, v30
    v_mov_b32 v187, v30
    v_mov_b32 v188, v31
    v_mov_b32 v189, v31
    v_mov_b32 v190, v31
    v_mov_b32 v191, v31
    v_mov_b32 v192, v32
    v_mov_b32 v193, v32
    v_mov_b32 v194, v32
    v_mov_b32 v195, v32
    v_mov_b32 v196, v33
    v_mov_b32 v197, v33
    v_mov_b32 v198, v33
    v_mov_b32 v199, v33
    s_waitcnt lgkmcnt(0)
    v_mov_b32 v200, v36
    v_mov_b32 v201, v36
    v_mov_b32 v202, v36
    v_mov_b32 v203, v36
    v_mov_b32 v204, v37
    v_mov_b32 v205, v37
    v_mov_b32 v206, v37
    v_mov_b32 v207, v37
    s_add_u32 m0, s33, 0x4000
    s_nop 0
    buffer_load_dwordx4 v20, s[16:19], s46 offen nt lds
    s_add_u32 m0, s33, 0x4000
    s_nop 0
    buffer_load_dwordx4 v21, s[16:19], s46 offen offset:1024 nt lds
    s_add_u32 m0, s33, 0x4000
    s_nop 0
    buffer_load_dwordx4 v22, s[16:19], s46 offen offset:2048 nt lds
    s_add_u32 m0, s33, 0x4000
    s_waitcnt vmcnt(0)
    s_branch L_mx
.section .rodata,"a"
.p2align 6
.amdhsa_kernel standalone__gqa_softmax__near_ridge_kernel
  .amdhsa_next_free_vgpr 512
  .amdhsa_next_free_sgpr 102
  .amdhsa_accum_offset 256
  .amdhsa_group_segment_fixed_size 0
  .amdhsa_kernarg_size 48
  .amdhsa_user_sgpr_count 2
  .amdhsa_user_sgpr_kernarg_segment_ptr 1
  .amdhsa_system_sgpr_workgroup_id_x 1
.end_amdhsa_kernel
```
